```python
import torch

def _softmax(x, axis=-1):
    return torch.softmax(x, dim=axis)
def _gelu(x):
    return torch.nn.functional.gelu(x, approximate="tanh")
def _silu(x):
    return torch.nn.functional.silu(x)
def _sigmoid(x):
    return torch.sigmoid(x)
def _layernorm(x, axis=-1, eps=1e-5):
    m = x.mean(dim=axis, keepdim=True)
    v = x.var(dim=axis, keepdim=True, unbiased=False)
    return (x - m) / torch.sqrt(v + eps)
def _scatter_add(tgt, idx, src, axis=0):
    return tgt.clone().index_add_(axis, idx, src)
def _segment_sum(src, seg, n):
    out = torch.zeros((n,) + src.shape[1:], dtype=src.dtype)
    return out.index_add_(0, seg, src)
def _pad(x, pw):
    flat = tuple(v for pair in reversed(pw) for v in pair)
    return torch.nn.functional.pad(x, flat)

kernel_name = 'concat_heads__gqa_block_cached__gqa_block_cached__decode'

def setup_inputs():

    _w = (lambda a: (lambda t: t.to(torch.bfloat16) if t.is_floating_point() else t)(torch.as_tensor(a)))
    def _A_setup():
        B, Sq, D = 4, 1, 512
        Hq, Hkv, Sk, Dh = 32, 8, 16384, 128
        assert Hq % Hkv == 0, (Hq, Hkv)
        return {
            "x": _w((lambda *s: torch.randn(*s, dtype=torch.bfloat16) * 0.8)(B, Sq, D)),
            "k_cache": _w((lambda *s: torch.randn(*s, dtype=torch.bfloat16) * 0.8)(B, Hkv, Sk, Dh)),
            "v_cache": _w((lambda *s: torch.randn(*s, dtype=torch.bfloat16) * 0.05)(B, Hkv, Sk, Dh)),
            "wq": _w((lambda *s: torch.randn(*s, dtype=torch.bfloat16) * 0.8)(D, Hq * Dh) * (D ** -0.5)),
            "wo": _w((lambda *s: torch.randn(*s, dtype=torch.bfloat16) * 0.05)(Hq * Dh, D) * ((Hq * Dh) ** -0.5)),
        }
    _A_in = _A_setup()

    def _B_setup():
        B, Sq, D = 4, 1, 512
        Hq, Hkv, Sk, Dh = 32, 8, 16384, 128
        assert Hq % Hkv == 0, (Hq, Hkv)
        return {
            "x": _w((lambda *s: torch.randn(*s, dtype=torch.bfloat16) * 0.8)(B, Sq, D)),
            "k_cache": _w((lambda *s: torch.randn(*s, dtype=torch.bfloat16) * 0.8)(B, Hkv, Sk, Dh)),
            "v_cache": _w((lambda *s: torch.randn(*s, dtype=torch.bfloat16) * 0.05)(B, Hkv, Sk, Dh)),
            "wq": _w((lambda *s: torch.randn(*s, dtype=torch.bfloat16) * 0.8)(D, Hq * Dh) * (D ** -0.5)),
            "wo": _w((lambda *s: torch.randn(*s, dtype=torch.bfloat16) * 0.05)(Hq * Dh, D) * ((Hq * Dh) ** -0.5)),
        }
    _B_in = _B_setup()

    return {
        "A_x": _A_in["x"],
        "A_k_cache": _A_in["k_cache"],
        "A_v_cache": _A_in["v_cache"],
        "A_wq": _A_in["wq"],
        "A_wo": _A_in["wo"],
        "B_x": _B_in["x"],
        "B_k_cache": _B_in["k_cache"],
        "B_v_cache": _B_in["v_cache"],
        "B_wq": _B_in["wq"],
        "B_wo": _B_in["wo"],
    }

def reference(A_x, A_k_cache, A_v_cache, A_wq, A_wo, B_x, B_k_cache, B_v_cache, B_wq, B_wo):
    def _A_ref(x, k_cache, v_cache, wq, wo):
        B, Sq, D = x.shape
        Hq, Dh = 32, 128
        Hkv = k_cache.shape[1]
        rep = Hq // Hkv
        q = (lambda x, *d: x.permute(*d))((x @ wq).reshape(B, Sq, Hq, Dh), 0, 2, 1, 3)
        k = (lambda x, n, axis: torch.repeat_interleave(x, n, dim=axis))(k_cache, rep, axis=1)
        v = (lambda x, n, axis: torch.repeat_interleave(x, n, dim=axis))(v_cache, rep, axis=1)
        scores = torch.einsum("bhqd,bhkd->bhqk", q, k) * (Dh ** -0.5)
        p = _softmax(scores, axis=-1)
        o = torch.einsum("bhqk,bhkd->bhqd", p, v)
        return (lambda x, *d: x.permute(*d))(o, 0, 2, 1, 3).reshape(B, Sq, Hq * Dh) @ wo

    def _B_ref(x, k_cache, v_cache, wq, wo):
        B, Sq, D = x.shape
        Hq, Dh = 32, 128
        Hkv = k_cache.shape[1]
        rep = Hq // Hkv
        q = (lambda x, *d: x.permute(*d))((x @ wq).reshape(B, Sq, Hq, Dh), 0, 2, 1, 3)
        k = (lambda x, n, axis: torch.repeat_interleave(x, n, dim=axis))(k_cache, rep, axis=1)
        v = (lambda x, n, axis: torch.repeat_interleave(x, n, dim=axis))(v_cache, rep, axis=1)
        scores = torch.einsum("bhqd,bhkd->bhqk", q, k) * (Dh ** -0.5)
        p = _softmax(scores, axis=-1)
        o = torch.einsum("bhqk,bhkd->bhqd", p, v)
        return (lambda x, *d: x.permute(*d))(o, 0, 2, 1, 3).reshape(B, Sq, Hq * Dh) @ wo

    a = _A_ref(A_x, A_k_cache, A_v_cache, A_wq, A_wo)
    b = _B_ref(B_x, B_k_cache, B_v_cache, B_wq, B_wo)
    return torch.concatenate([a, b], axis=-1)
```

```asm
; @launch grid=(256,1,1) block=(320,1,1) lds=89088
.amdgcn_target "amdgcn-amd-amdhsa--gfx950"
.text
.globl concat_heads__gqa_block_cached__gqa_block_cached__decode_kernel
.p2align 8
.type concat_heads__gqa_block_cached__gqa_block_cached__decode_kernel,@function
concat_heads__gqa_block_cached__gqa_block_cached__decode_kernel:
s_cmp_ge_u32 s2, 256
s_cbranch_scc1 L_end
s_bfe_u32 s28, s2, 0x10001
s_mul_i32 s32, s28, 40
s_load_dwordx2 s[16:17], s[0:1], s32
s_add_u32 s32, s32, 24
s_load_dwordx4 s[44:47], s[0:1], s32
s_load_dwordx2 s[20:21], s[0:1], 96
s_load_dwordx4 s[4:7], s[0:1], 8
s_load_dwordx4 s[8:11], s[0:1], 48
s_load_dwordx2 s[48:49], s[0:1], 80
v_lshrrev_b32 v1, 6, v0
v_and_b32 v0, 63, v0
v_readfirstlane_b32 s33, v1
s_lshr_b32 s34, s2, 6
s_bfe_u32 s29, s2, 0x20004
s_lshl_b32 s29, s29, 1
s_bfe_u32 s36, s2, 0x10002
s_add_u32 s29, s29, s36
s_bfe_u32 s37, s2, 0x10003
s_and_b32 s35, s2, 3
s_lshl_b32 s35, s35, 1
s_add_u32 s35, s35, s37
s_and_b32 s30, s35, 3
s_lshl_b32 s36, s34, 2
s_add_u32 s30, s30, s36
s_lshl_b32 s31, s29, 2
s_add_u32 s31, s31, s34
s_lshl_b32 s32, s31, 3
s_add_u32 s32, s32, s35
s_mul_i32 s32, s32, 2176
s_add_u32 s32, s32, 0x200000
s_mov_b32 s40, 0x05040100
s_mov_b32 s41, 0x07060302
s_mov_b32 s64, 8388608
s_mov_b32 s22, 0x340000
s_mov_b32 s23, 0x20000
s_cmp_lg_u32 s33, 0
s_cbranch_scc1 L_stream
s_setprio 3
v_bfe_u32 v1, v0, 2, 2
v_lshlrev_b32 v1, 18, v1
v_lshrrev_b32 v2, 4, v0
v_lshl_add_u32 v1, v2, 16, v1
v_and_b32 v2, 3, v0
v_lshl_add_u32 v1, v2, 4, v1
v_lshlrev_b32 v3, 10, v2
v_bfe_u32 v2, v0, 2, 2
v_lshl_add_u32 v3, v2, 6, v3
v_lshrrev_b32 v2, 4, v0
v_lshl_add_u32 v3, v2, 4, v3
s_lshl_b32 s56, s29, 10
s_lshl_b32 s37, s30, 6
s_add_u32 s56, s56, s37
v_mov_b32 v14, 0
v_mov_b32 v8, 0
v_mov_b32 v9, 0
v_mov_b32 v10, 0
v_mov_b32 v11, 0
ds_write_b128 v14, v[8:11] offset:2064
ds_write_b64 v14, v[8:9] offset:2056
v_mov_b32 v192, -1
v_mov_b32 v193, -1
v_mov_b32 v194, -1
v_mov_b32 v195, -1
v_lshlrev_b32 v2, 4, v0
v_lshlrev_b32 v13, 3, v0
v_mov_b32 v8, 1
s_add_u32 s39, s32, 0x88000
s_mov_b32 s37, 0x20000
s_lshl_b32 s38, s31, 11
s_mov_b32 s54, 0
s_mov_b32 s18, 4096
s_mov_b32 s19, 0x20000
s_mov_b32 s14, 0x400000
s_mov_b32 s15, 0x20000
s_waitcnt lgkmcnt(0)
s_mov_b32 s12, s44
s_mov_b32 s13, s45
buffer_load_dword v15, v14, s[20:23], s37 offen sc1
buffer_load_dwordx4 v[176:179], v3, s[16:19], 0 offen offset:0
buffer_load_dwordx4 v[180:183], v3, s[16:19], 0 offen offset:256
buffer_load_dwordx4 v[184:187], v3, s[16:19], 0 offen offset:512
buffer_load_dwordx4 v[188:191], v3, s[16:19], 0 offen offset:768
buffer_load_dwordx4 v[48:51], v1, s[12:15], s56 offen nt
s_add_u32 s37, s56, 0x2000
buffer_load_dwordx4 v[52:55], v1, s[12:15], s37 offen nt
s_add_u32 s37, s56, 0x4000
buffer_load_dwordx4 v[56:59], v1, s[12:15], s37 offen nt
s_add_u32 s37, s56, 0x6000
buffer_load_dwordx4 v[60:63], v1, s[12:15], s37 offen nt
s_add_u32 s37, s56, 0x8000
buffer_load_dwordx4 v[64:67], v1, s[12:15], s37 offen nt
s_add_u32 s37, s56, 0xa000
buffer_load_dwordx4 v[68:71], v1, s[12:15], s37 offen nt
s_add_u32 s37, s56, 0xc000
buffer_load_dwordx4 v[72:75], v1, s[12:15], s37 offen nt
s_add_u32 s37, s56, 0xe000
buffer_load_dwordx4 v[76:79], v1, s[12:15], s37 offen nt
s_add_u32 s37, s56, 0x100000
buffer_load_dwordx4 v[80:83], v1, s[12:15], s37 offen nt
s_add_u32 s37, s56, 0x102000
buffer_load_dwordx4 v[84:87], v1, s[12:15], s37 offen nt
s_add_u32 s37, s56, 0x104000
buffer_load_dwordx4 v[88:91], v1, s[12:15], s37 offen nt
s_add_u32 s37, s56, 0x106000
buffer_load_dwordx4 v[92:95], v1, s[12:15], s37 offen nt
s_add_u32 s37, s56, 0x108000
buffer_load_dwordx4 v[96:99], v1, s[12:15], s37 offen nt
s_add_u32 s37, s56, 0x10a000
buffer_load_dwordx4 v[100:103], v1, s[12:15], s37 offen nt
s_add_u32 s37, s56, 0x10c000
buffer_load_dwordx4 v[104:107], v1, s[12:15], s37 offen nt
s_add_u32 s37, s56, 0x10e000
buffer_load_dwordx4 v[108:111], v1, s[12:15], s37 offen nt
s_add_u32 s37, s56, 0x200000
buffer_load_dwordx4 v[112:115], v1, s[12:15], s37 offen nt
s_add_u32 s37, s56, 0x202000
buffer_load_dwordx4 v[116:119], v1, s[12:15], s37 offen nt
s_add_u32 s37, s56, 0x204000
buffer_load_dwordx4 v[120:123], v1, s[12:15], s37 offen nt
s_add_u32 s37, s56, 0x206000
buffer_load_dwordx4 v[124:127], v1, s[12:15], s37 offen nt
s_add_u32 s37, s56, 0x208000
buffer_load_dwordx4 v[128:131], v1, s[12:15], s37 offen nt
s_add_u32 s37, s56, 0x20a000
buffer_load_dwordx4 v[132:135], v1, s[12:15], s37 offen nt
s_add_u32 s37, s56, 0x20c000
buffer_load_dwordx4 v[136:139], v1, s[12:15], s37 offen nt
s_add_u32 s37, s56, 0x20e000
buffer_load_dwordx4 v[140:143], v1, s[12:15], s37 offen nt
s_add_u32 s37, s56, 0x300000
buffer_load_dwordx4 v[144:147], v1, s[12:15], s37 offen nt
s_add_u32 s37, s56, 0x302000
buffer_load_dwordx4 v[148:151], v1, s[12:15], s37 offen nt
s_add_u32 s37, s56, 0x304000
buffer_load_dwordx4 v[152:155], v1, s[12:15], s37 offen nt
s_add_u32 s37, s56, 0x306000
buffer_load_dwordx4 v[156:159], v1, s[12:15], s37 offen nt
s_add_u32 s37, s56, 0x308000
buffer_load_dwordx4 v[160:163], v1, s[12:15], s37 offen nt
s_add_u32 s37, s56, 0x30a000
buffer_load_dwordx4 v[164:167], v1, s[12:15], s37 offen nt
s_add_u32 s37, s56, 0x30c000
buffer_load_dwordx4 v[168:171], v1, s[12:15], s37 offen nt
s_add_u32 s37, s56, 0x30e000
buffer_load_dwordx4 v[172:175], v1, s[12:15], s37 offen nt
buffer_store_dwordx4 v[192:195], v2, s[20:23], s32 offen sc1
buffer_store_dwordx4 v[192:195], v2, s[20:23], s32 offen offset:1024 sc1
buffer_store_dwordx4 v[192:195], v2, s[20:23], s39 offen sc1
buffer_store_dwordx4 v[192:195], v2, s[20:23], s39 offen offset:1024 sc1
s_barrier
s_waitcnt vmcnt(40)
v_add_u32 v15, 0x9e3779b1, v15
v_mov_b32 v10, 20
v_mov_b32 v11, v15
v_readfirstlane_b32 s55, v15
ds_write_b64 v14, v[10:11] offset:2048
v_lshrrev_b32 v4, 4, v0
v_bfe_u32 v5, v0, 2, 2
v_cmp_eq_u32 s[58:59], v4, v5
v_lshlrev_b32 v4, 9, v4
v_and_b32 v5, 3, v0
v_lshl_add_u32 v4, v5, 7, v4
v_lshrrev_b32 v6, 4, v0
v_lshlrev_b32 v6, 7, v6
v_lshl_add_u32 v6, v5, 5, v6
v_bfe_u32 v5, v0, 2, 2
v_lshl_add_u32 v6, v5, 2, v6
v_add_u32 v6, 3584, v6
v_add_u32 v7, 1024, v6
v_lshrrev_b32 v12, 4, v0
v_lshlrev_b32 v12, 11, v12
v_and_b32 v5, 15, v0
v_lshl_add_u32 v12, v5, 3, v12
s_lshl_b32 s36, s28, 3
s_add_u32 s36, s36, s29
s_lshl_b32 s36, s36, 13
s_lshl_b32 s37, s30, 7
s_add_u32 s36, s36, s37
s_waitcnt vmcnt(28)
v_perm_b32 v16, v52, v48, s40
v_perm_b32 v20, v52, v48, s41
v_perm_b32 v17, v60, v56, s40
v_perm_b32 v21, v60, v56, s41
v_perm_b32 v18, v68, v64, s40
v_perm_b32 v22, v68, v64, s41
v_perm_b32 v19, v76, v72, s40
v_perm_b32 v23, v76, v72, s41
v_perm_b32 v24, v53, v49, s40
v_perm_b32 v28, v53, v49, s41
v_perm_b32 v25, v61, v57, s40
v_perm_b32 v29, v61, v57, s41
v_perm_b32 v26, v69, v65, s40
v_perm_b32 v30, v69, v65, s41
v_perm_b32 v27, v77, v73, s40
v_perm_b32 v31, v77, v73, s41
v_perm_b32 v32, v54, v50, s40
v_perm_b32 v36, v54, v50, s41
v_perm_b32 v33, v62, v58, s40
v_perm_b32 v37, v62, v58, s41
v_perm_b32 v34, v70, v66, s40
v_perm_b32 v38, v70, v66, s41
v_perm_b32 v35, v78, v74, s40
v_perm_b32 v39, v78, v74, s41
v_perm_b32 v40, v55, v51, s40
v_perm_b32 v44, v55, v51, s41
v_perm_b32 v41, v63, v59, s40
v_perm_b32 v45, v63, v59, s41
v_perm_b32 v42, v71, v67, s40
v_perm_b32 v46, v71, v67, s41
v_perm_b32 v43, v79, v75, s40
v_perm_b32 v47, v79, v75, s41
s_waitcnt vmcnt(20)
v_perm_b32 v48, v84, v80, s40
v_perm_b32 v52, v84, v80, s41
v_perm_b32 v49, v92, v88, s40
v_perm_b32 v53, v92, v88, s41
v_perm_b32 v50, v100, v96, s40
v_perm_b32 v54, v100, v96, s41
v_perm_b32 v51, v108, v104, s40
v_perm_b32 v55, v108, v104, s41
v_perm_b32 v56, v85, v81, s40
v_perm_b32 v60, v85, v81, s41
v_perm_b32 v57, v93, v89, s40
v_perm_b32 v61, v93, v89, s41
v_perm_b32 v58, v101, v97, s40
v_perm_b32 v62, v101, v97, s41
v_perm_b32 v59, v109, v105, s40
v_perm_b32 v63, v109, v105, s41
v_perm_b32 v64, v86, v82, s40
v_perm_b32 v68, v86, v82, s41
v_perm_b32 v65, v94, v90, s40
v_perm_b32 v69, v94, v90, s41
v_perm_b32 v66, v102, v98, s40
v_perm_b32 v70, v102, v98, s41
v_perm_b32 v67, v110, v106, s40
v_perm_b32 v71, v110, v106, s41
v_perm_b32 v72, v87, v83, s40
v_perm_b32 v76, v87, v83, s41
v_perm_b32 v73, v95, v91, s40
v_perm_b32 v77, v95, v91, s41
v_perm_b32 v74, v103, v99, s40
v_perm_b32 v78, v103, v99, s41
v_perm_b32 v75, v111, v107, s40
v_perm_b32 v79, v111, v107, s41
s_waitcnt vmcnt(12)
v_perm_b32 v80, v116, v112, s40
v_perm_b32 v84, v116, v112, s41
v_perm_b32 v81, v124, v120, s40
v_perm_b32 v85, v124, v120, s41
v_perm_b32 v82, v132, v128, s40
v_perm_b32 v86, v132, v128, s41
v_perm_b32 v83, v140, v136, s40
v_perm_b32 v87, v140, v136, s41
v_perm_b32 v88, v117, v113, s40
v_perm_b32 v92, v117, v113, s41
v_perm_b32 v89, v125, v121, s40
v_perm_b32 v93, v125, v121, s41
v_perm_b32 v90, v133, v129, s40
v_perm_b32 v94, v133, v129, s41
v_perm_b32 v91, v141, v137, s40
v_perm_b32 v95, v141, v137, s41
v_perm_b32 v96, v118, v114, s40
v_perm_b32 v100, v118, v114, s41
v_perm_b32 v97, v126, v122, s40
v_perm_b32 v101, v126, v122, s41
v_perm_b32 v98, v134, v130, s40
v_perm_b32 v102, v134, v130, s41
v_perm_b32 v99, v142, v138, s40
v_perm_b32 v103, v142, v138, s41
v_perm_b32 v104, v119, v115, s40
v_perm_b32 v108, v119, v115, s41
v_perm_b32 v105, v127, v123, s40
v_perm_b32 v109, v127, v123, s41
v_perm_b32 v106, v135, v131, s40
v_perm_b32 v110, v135, v131, s41
v_perm_b32 v107, v143, v139, s40
v_perm_b32 v111, v143, v139, s41
s_waitcnt vmcnt(4)
v_perm_b32 v112, v148, v144, s40
v_perm_b32 v116, v148, v144, s41
v_perm_b32 v113, v156, v152, s40
v_perm_b32 v117, v156, v152, s41
v_perm_b32 v114, v164, v160, s40
v_perm_b32 v118, v164, v160, s41
v_perm_b32 v115, v172, v168, s40
v_perm_b32 v119, v172, v168, s41
v_perm_b32 v120, v149, v145, s40
v_perm_b32 v124, v149, v145, s41
v_perm_b32 v121, v157, v153, s40
v_perm_b32 v125, v157, v153, s41
v_perm_b32 v122, v165, v161, s40
v_perm_b32 v126, v165, v161, s41
v_perm_b32 v123, v173, v169, s40
v_perm_b32 v127, v173, v169, s41
v_perm_b32 v128, v150, v146, s40
v_perm_b32 v132, v150, v146, s41
v_perm_b32 v129, v158, v154, s40
v_perm_b32 v133, v158, v154, s41
v_perm_b32 v130, v166, v162, s40
v_perm_b32 v134, v166, v162, s41
v_perm_b32 v131, v174, v170, s40
v_perm_b32 v135, v174, v170, s41
v_perm_b32 v136, v151, v147, s40
v_perm_b32 v140, v151, v147, s41
v_perm_b32 v137, v159, v155, s40
v_perm_b32 v141, v159, v155, s41
v_perm_b32 v138, v167, v163, s40
v_perm_b32 v142, v167, v163, s41
v_perm_b32 v139, v175, v171, s40
v_perm_b32 v143, v175, v171, s41
s_nop 0
v_mfma_f32_16x16x32_bf16 v[144:147], v[16:19], v[176:179], 0
v_mfma_f32_16x16x32_bf16 v[148:151], v[20:23], v[176:179], 0
v_mfma_f32_16x16x32_bf16 v[152:155], v[24:27], v[176:179], 0
v_mfma_f32_16x16x32_bf16 v[156:159], v[28:31], v[176:179], 0
v_mfma_f32_16x16x32_bf16 v[160:163], v[32:35], v[176:179], 0
v_mfma_f32_16x16x32_bf16 v[164:167], v[36:39], v[176:179], 0
v_mfma_f32_16x16x32_bf16 v[168:171], v[40:43], v[176:179], 0
v_mfma_f32_16x16x32_bf16 v[172:175], v[44:47], v[176:179], 0
v_mfma_f32_16x16x32_bf16 v[144:147], v[48:51], v[180:183], v[144:147]
v_mfma_f32_16x16x32_bf16 v[148:151], v[52:55], v[180:183], v[148:151]
v_mfma_f32_16x16x32_bf16 v[152:155], v[56:59], v[180:183], v[152:155]
v_mfma_f32_16x16x32_bf16 v[156:159], v[60:63], v[180:183], v[156:159]
v_mfma_f32_16x16x32_bf16 v[160:163], v[64:67], v[180:183], v[160:163]
v_mfma_f32_16x16x32_bf16 v[164:167], v[68:71], v[180:183], v[164:167]
v_mfma_f32_16x16x32_bf16 v[168:171], v[72:75], v[180:183], v[168:171]
v_mfma_f32_16x16x32_bf16 v[172:175], v[76:79], v[180:183], v[172:175]
v_mfma_f32_16x16x32_bf16 v[144:147], v[80:83], v[184:187], v[144:147]
v_mfma_f32_16x16x32_bf16 v[148:151], v[84:87], v[184:187], v[148:151]
v_mfma_f32_16x16x32_bf16 v[152:155], v[88:91], v[184:187], v[152:155]
v_mfma_f32_16x16x32_bf16 v[156:159], v[92:95], v[184:187], v[156:159]
v_mfma_f32_16x16x32_bf16 v[160:163], v[96:99], v[184:187], v[160:163]
v_mfma_f32_16x16x32_bf16 v[164:167], v[100:103], v[184:187], v[164:167]
v_mfma_f32_16x16x32_bf16 v[168:171], v[104:107], v[184:187], v[168:171]
v_mfma_f32_16x16x32_bf16 v[172:175], v[108:111], v[184:187], v[172:175]
v_mfma_f32_16x16x32_bf16 v[144:147], v[112:115], v[188:191], v[144:147]
v_mfma_f32_16x16x32_bf16 v[148:151], v[116:119], v[188:191], v[148:151]
v_mfma_f32_16x16x32_bf16 v[152:155], v[120:123], v[188:191], v[152:155]
v_mfma_f32_16x16x32_bf16 v[156:159], v[124:127], v[188:191], v[156:159]
v_mfma_f32_16x16x32_bf16 v[160:163], v[128:131], v[188:191], v[160:163]
v_mfma_f32_16x16x32_bf16 v[164:167], v[132:135], v[188:191], v[164:167]
v_mfma_f32_16x16x32_bf16 v[168:171], v[136:139], v[188:191], v[168:171]
v_mfma_f32_16x16x32_bf16 v[172:175], v[140:143], v[188:191], v[172:175]
s_mov_b64 exec, s[58:59]
s_nop 0
ds_write_b128 v4, v[144:147] offset:3584
ds_write_b128 v4, v[148:151] offset:3600
ds_write_b128 v4, v[152:155] offset:3616
ds_write_b128 v4, v[156:159] offset:3632
ds_write_b128 v4, v[160:163] offset:3648
ds_write_b128 v4, v[164:167] offset:3664
ds_write_b128 v4, v[168:171] offset:3680
ds_write_b128 v4, v[172:175] offset:3696
s_mov_b64 exec, -1
ds_read2_b32 v[16:17], v6 offset0:0 offset1:4
ds_read2_b32 v[18:19], v6 offset0:128 offset1:132
ds_read2_b32 v[20:21], v7 offset0:0 offset1:4
ds_read2_b32 v[22:23], v7 offset0:128 offset1:132
s_waitcnt lgkmcnt(0)
v_add_f32 v16, v16, v18
v_add_f32 v17, v17, v19
v_add_f32 v20, v20, v22
v_add_f32 v21, v21, v23
v_add_f32 v16, v16, v20
v_add_f32 v17, v17, v21
v_cvt_pk_bf16_f32 v10, v16, v17
s_waitcnt vmcnt(0)
buffer_store_dwordx2 v[10:11], v12, s[20:23], s36 offen offset:0 sc1
s_waitcnt vmcnt(0)
L_pollq:
buffer_load_dwordx4 v[16:19], v2, s[20:23], s38 offen offset:0 sc1
buffer_load_dwordx4 v[20:23], v2, s[20:23], s38 offen offset:1024 sc1
s_waitcnt vmcnt(0)
v_xor_b32 v17, s55, v17
v_xor_b32 v19, s55, v19
v_xor_b32 v21, s55, v21
v_xor_b32 v23, s55, v23
v_or3_b32 v17, v17, v19, v21
v_or_b32 v17, v17, v23
v_cmp_ne_u32 vcc, 0, v17
s_cbranch_vccz L_gotq
s_sub_u32 s64, s64, 1
s_cmp_gt_i32 s64, 0
s_cbranch_scc1 L_pollq
L_gotq:
s_cmp_ge_u32 s54, 2
s_cbranch_scc1 L_gotr
ds_write2_b32 v13, v16, v18 offset0:0 offset1:1
ds_write2_b32 v13, v20, v22 offset0:128 offset1:129
ds_write_b32 v9, v8 offset:2064
s_cmp_lg_u32 s54, 0
s_cbranch_scc1 L_gotw
s_mov_b32 s54, 1
s_add_u32 s38, s38, 0x10000
v_add_u32 v13, 1024, v13
v_mov_b32 v9, 4
s_branch L_pollq
L_gotw:
s_lshr_b32 s38, s2, 5
s_lshl_b32 s38, s38, 13
s_mov_b32 s54, 2
s_branch L_pollq
L_gotr:
s_add_u32 s54, s54, 1
s_add_u32 s38, s38, 0x10000
s_cmp_eq_u32 s54, 3
s_cbranch_scc1 L_pollq
s_getreg_b32 s53, hwreg(HW_REG_XCC_ID, 0, 4)
s_and_b32 s52, s2, 7
s_lshl_b32 s52, s52, 10
s_add_u32 s52, s52, 0x2c000
s_lshr_b32 s36, s2, 3
s_lshl_b32 s36, s36, 5
s_add_u32 s36, s36, s52
v_mov_b32 v10, s53
s_mov_b64 exec, 1
buffer_store_dwordx2 v[10:11], v14, s[20:23], s36 offen sc1
s_mov_b64 exec, -1
s_mov_b32 s6, 0x30000
s_lshr_b32 s7, s2, 2
s_mul_i32 s7, s7, 1152
s_and_b32 s36, s2, 3
s_lshl_b32 s36, s36, 2
s_add_u32 s7, s7, s36
s_bfe_u32 s8, s2, 0x30003
s_mul_i32 s8, s8, 1152
s_lshl_b32 s4, s31, 9
s_add_u32 s4, s4, 0x24000
s_lshl_b32 s5, s35, 6
s_add_u32 s5, s5, s4
s_mov_b32 s42, 0x3e0293ee
v_and_b32 v3, 3, v0
v_lshlrev_b32 v3, 2, v3
v_and_b32 v4, 0x1f0, v2
s_movk_i32 s9, 64
s_call_b64 s[58:59], L_evb
s_movk_i32 s9, 80
s_mov_b32 s11, 0
s_call_b64 s[58:59], L_evp
s_movk_i32 s9, 112
s_mov_b32 s11, 0
s_call_b64 s[58:59], L_evg
s_movk_i32 s9, 128
s_call_b64 s[58:59], L_evb
s_movk_i32 s9, 150
s_mov_b32 s11, 0
s_call_b64 s[58:59], L_evx
s_movk_i32 s9, 192
s_call_b64 s[58:59], L_evb
s_movk_i32 s9, 205
s_mov_b32 s11, 1
s_call_b64 s[58:59], L_evp
s_movk_i32 s9, 214
s_call_b64 s[58:59], L_evb
s_movk_i32 s9, 222
s_mov_b32 s11, 1
s_call_b64 s[58:59], L_evg
s_movk_i32 s9, 230
s_call_b64 s[58:59], L_evb
s_movk_i32 s9, 242
s_call_b64 s[58:59], L_evb
s_branch L_hdone
L_evb:
s_sub_u32 s10, s9, 5
L_progb:
ds_read_b32 v10, v14 offset:2048
s_waitcnt lgkmcnt(0)
v_readfirstlane_b32 s37, v10
s_cmp_ge_u32 s37, s9
s_cbranch_scc1 L_progdoneb
s_cmp_ge_u32 s37, s10
s_cbranch_scc1 L_progsb
s_sleep 16
L_progsb:
s_sleep 1
s_sub_u32 s64, s64, 1
s_cmp_gt_i32 s64, 0
s_cbranch_scc1 L_progb
L_progdoneb:
s_memrealtime s[60:61]
s_add_u32 s36, s6, s7
s_add_u32 s37, s6, s8
s_add_u32 s62, s20, s37
s_addc_u32 s63, s21, 0
s_waitcnt lgkmcnt(0)
v_mov_b32 v20, s60
s_mov_b64 exec, 1
buffer_store_dword v20, v14, s[20:23], s36 offen sc1
s_mov_b64 exec, -1
s_load_dwordx4 s[12:15], s[62:63], 0x0 glc
s_load_dwordx4 s[16:19], s[62:63], 0x1f80 glc
s_load_dwordx4 s[24:27], s[62:63], 0x3f00 glc
s_load_dwordx4 s[28:31], s[62:63], 0x5e80 glc
s_load_dwordx4 s[32:35], s[62:63], 0x7e00 glc
s_load_dwordx4 s[44:47], s[62:63], 0x9d80 glc
s_load_dwordx4 s[48:51], s[62:63], 0xbd00 glc
s_load_dwordx4 s[96:99], s[62:63], 0xdc80 glc
s_add_u32 s6, s6, 73728
s_mov_b32 s36, 0
s_waitcnt lgkmcnt(0)
ds_read_b32 v10, v14 offset:2048
s_sub_u32 s37, s60, s12
s_cmpk_lt_u32 s37, 1000
s_cselect_b32 s37, s37, 0
s_add_u32 s36, s36, s37
s_sub_u32 s37, s60, s13
s_cmpk_lt_u32 s37, 1000
s_cselect_b32 s37, s37, 0
s_add_u32 s36, s36, s37
s_sub_u32 s37, s60, s14
s_cmpk_lt_u32 s37, 1000
s_cselect_b32 s37, s37, 0
s_add_u32 s36, s36, s37
s_sub_u32 s37, s60, s15
s_cmpk_lt_u32 s37, 1000
s_cselect_b32 s37, s37, 0
s_add_u32 s36, s36, s37
s_sub_u32 s37, s60, s16
s_cmpk_lt_u32 s37, 1000
s_cselect_b32 s37, s37, 0
s_add_u32 s36, s36, s37
s_sub_u32 s37, s60, s17
s_cmpk_lt_u32 s37, 1000
s_cselect_b32 s37, s37, 0
s_add_u32 s36, s36, s37
s_sub_u32 s37, s60, s18
s_cmpk_lt_u32 s37, 1000
s_cselect_b32 s37, s37, 0
s_add_u32 s36, s36, s37
s_sub_u32 s37, s60, s19
s_cmpk_lt_u32 s37, 1000
s_cselect_b32 s37, s37, 0
s_add_u32 s36, s36, s37
s_sub_u32 s37, s60, s24
s_cmpk_lt_u32 s37, 1000
s_cselect_b32 s37, s37, 0
s_add_u32 s36, s36, s37
s_sub_u32 s37, s60, s25
s_cmpk_lt_u32 s37, 1000
s_cselect_b32 s37, s37, 0
s_add_u32 s36, s36, s37
s_sub_u32 s37, s60, s26
s_cmpk_lt_u32 s37, 1000
s_cselect_b32 s37, s37, 0
s_add_u32 s36, s36, s37
s_sub_u32 s37, s60, s27
s_cmpk_lt_u32 s37, 1000
s_cselect_b32 s37, s37, 0
s_add_u32 s36, s36, s37
s_sub_u32 s37, s60, s28
s_cmpk_lt_u32 s37, 1000
s_cselect_b32 s37, s37, 0
s_add_u32 s36, s36, s37
s_sub_u32 s37, s60, s29
s_cmpk_lt_u32 s37, 1000
s_cselect_b32 s37, s37, 0
s_add_u32 s36, s36, s37
s_sub_u32 s37, s60, s30
s_cmpk_lt_u32 s37, 1000
s_cselect_b32 s37, s37, 0
s_add_u32 s36, s36, s37
s_sub_u32 s37, s60, s31
s_cmpk_lt_u32 s37, 1000
s_cselect_b32 s37, s37, 0
s_add_u32 s36, s36, s37
s_sub_u32 s37, s60, s32
s_cmpk_lt_u32 s37, 1000
s_cselect_b32 s37, s37, 0
s_add_u32 s36, s36, s37
s_sub_u32 s37, s60, s33
s_cmpk_lt_u32 s37, 1000
s_cselect_b32 s37, s37, 0
s_add_u32 s36, s36, s37
s_sub_u32 s37, s60, s34
s_cmpk_lt_u32 s37, 1000
s_cselect_b32 s37, s37, 0
s_add_u32 s36, s36, s37
s_sub_u32 s37, s60, s35
s_cmpk_lt_u32 s37, 1000
s_cselect_b32 s37, s37, 0
s_add_u32 s36, s36, s37
s_sub_u32 s37, s60, s44
s_cmpk_lt_u32 s37, 1000
s_cselect_b32 s37, s37, 0
s_add_u32 s36, s36, s37
s_sub_u32 s37, s60, s45
s_cmpk_lt_u32 s37, 1000
s_cselect_b32 s37, s37, 0
s_add_u32 s36, s36, s37
s_sub_u32 s37, s60, s46
s_cmpk_lt_u32 s37, 1000
s_cselect_b32 s37, s37, 0
s_add_u32 s36, s36, s37
s_sub_u32 s37, s60, s47
s_cmpk_lt_u32 s37, 1000
s_cselect_b32 s37, s37, 0
s_add_u32 s36, s36, s37
s_sub_u32 s37, s60, s48
s_cmpk_lt_u32 s37, 1000
s_cselect_b32 s37, s37, 0
s_add_u32 s36, s36, s37
s_sub_u32 s37, s60, s49
s_cmpk_lt_u32 s37, 1000
s_cselect_b32 s37, s37, 0
s_add_u32 s36, s36, s37
s_sub_u32 s37, s60, s50
s_cmpk_lt_u32 s37, 1000
s_cselect_b32 s37, s37, 0
s_add_u32 s36, s36, s37
s_sub_u32 s37, s60, s51
s_cmpk_lt_u32 s37, 1000
s_cselect_b32 s37, s37, 0
s_add_u32 s36, s36, s37
s_sub_u32 s37, s60, s96
s_cmpk_lt_u32 s37, 1000
s_cselect_b32 s37, s37, 0
s_add_u32 s36, s36, s37
s_sub_u32 s37, s60, s97
s_cmpk_lt_u32 s37, 1000
s_cselect_b32 s37, s37, 0
s_add_u32 s36, s36, s37
s_sub_u32 s37, s60, s98
s_cmpk_lt_u32 s37, 1000
s_cselect_b32 s37, s37, 0
s_add_u32 s36, s36, s37
s_sub_u32 s37, s60, s99
s_cmpk_lt_u32 s37, 1000
s_cselect_b32 s37, s37, 0
s_add_u32 s36, s36, s37
s_lshr_b32 s36, s36, 5
s_sub_i32 s36, s36, 5
s_max_i32 s36, s36, 0
s_mul_i32 s36, s36, 36
s_lshr_b32 s36, s36, 8
s_waitcnt lgkmcnt(0)
v_add_u32 v10, s36, v10
ds_write_b32 v14, v10 offset:2056
s_setpc_b64 s[58:59]
L_evp:
s_sub_u32 s10, s9, 5
L_progp:
ds_read_b32 v10, v14 offset:2048
s_waitcnt lgkmcnt(0)
v_readfirstlane_b32 s37, v10
s_cmp_ge_u32 s37, s9
s_cbranch_scc1 L_progdonep
s_cmp_ge_u32 s37, s10
s_cbranch_scc1 L_progsp
s_sleep 16
L_progsp:
s_sleep 1
s_sub_u32 s64, s64, 1
s_cmp_gt_i32 s64, 0
s_cbranch_scc1 L_progp
L_progdonep:
s_lshl_b32 s36, s11, 2
v_mov_b32 v5, s36
L_evp1:
ds_read_b32 v10, v5 offset:2072
s_waitcnt lgkmcnt(0)
v_readfirstlane_b32 s37, v10
s_cmp_ge_u32 s37, 4
s_cbranch_scc1 L_evp2
s_sleep 2
s_sub_u32 s64, s64, 1
s_cmp_gt_i32 s64, 0
s_cbranch_scc1 L_evp1
L_evp2:
s_lshl_b32 s36, s11, 6
s_add_u32 s36, s36, 2112
v_add_u32 v5, s36, v3
ds_read2_b32 v[16:17], v5 offset0:0 offset1:4
ds_read2_b32 v[18:19], v5 offset0:8 offset1:12
ds_read2_b32 v[20:21], v5 offset0:32 offset1:36
ds_read2_b32 v[22:23], v5 offset0:40 offset1:44
s_lshl_b32 s36, s11, 14
s_add_u32 s36, s36, s5
s_waitcnt lgkmcnt(0)
v_max3_f32 v24, v16, v17, v18
v_max_f32 v24, v24, v19
v_mul_f32 v24, s42, v24
v_mul_f32 v16, s42, v16
v_mul_f32 v17, s42, v17
v_mul_f32 v18, s42, v18
v_mul_f32 v19, s42, v19
v_sub_f32 v16, v16, v24
v_sub_f32 v17, v17, v24
v_sub_f32 v18, v18, v24
v_sub_f32 v19, v19, v24
v_exp_f32 v16, v16
v_exp_f32 v17, v17
v_exp_f32 v18, v18
v_exp_f32 v19, v19
v_mov_b32 v25, v15
v_mov_b32 v27, v15
v_mul_f32 v26, v16, v20
v_fmac_f32 v26, v17, v21
v_fmac_f32 v26, v18, v22
v_fmac_f32 v26, v19, v23
s_mov_b64 exec, 15
buffer_store_dwordx4 v[24:27], v2, s[20:23], s36 offen sc1
s_mov_b64 exec, -1
s_setpc_b64 s[58:59]
L_evg:
s_sub_u32 s10, s9, 5
L_progg:
ds_read_b32 v10, v14 offset:2048
s_waitcnt lgkmcnt(0)
v_readfirstlane_b32 s37, v10
s_cmp_ge_u32 s37, s9
s_cbranch_scc1 L_progdoneg
s_cmp_ge_u32 s37, s10
s_cbranch_scc1 L_progsg
s_sleep 16
L_progsg:
s_sleep 1
s_sub_u32 s64, s64, 1
s_cmp_gt_i32 s64, 0
s_cbranch_scc1 L_progg
L_progdoneg:
s_lshl_b32 s36, s11, 14
s_add_u32 s36, s36, s4
L_evg1:
buffer_load_dwordx4 v[16:19], v4, s[20:23], s36 offen sc1
s_waitcnt vmcnt(0)
v_xor_b32 v17, v15, v17
v_xor_b32 v19, v15, v19
v_or_b32 v17, v17, v19
v_cmp_ne_u32 vcc, 0, v17
s_cbranch_vccz L_evg2
s_sleep 8
s_sub_u32 s64, s64, 1
s_cmp_gt_i32 s64, 0
s_cbranch_scc1 L_evg1
L_evg2:
v_mov_b32 v20, v16
s_nop 1
v_max_f32_dpp v20, v20, v20 row_ror:4 row_mask:0xf bank_mask:0xf
s_nop 1
v_max_f32_dpp v20, v20, v20 row_ror:8 row_mask:0xf bank_mask:0xf
v_mov_b32 v21, v20
s_nop 1
v_permlane16_swap_b32 v20, v21
v_max_f32 v20, v20, v21
v_sub_f32 v16, v16, v20
v_sub_f32 v17, v24, v20
v_exp_f32 v16, v16
v_exp_f32 v17, v17
s_nop 0
v_mul_f32 v18, v18, v16
s_nop 1
v_add_f32_dpp v18, v18, v18 row_ror:4 row_mask:0xf bank_mask:0xf
s_nop 1
v_add_f32_dpp v18, v18, v18 row_ror:8 row_mask:0xf bank_mask:0xf
v_mov_b32 v21, v18
s_nop 1
v_permlane16_swap_b32 v18, v21
v_add_f32 v18, v18, v21
v_rcp_f32 v18, v18
s_lshl_b32 s36, s11, 4
v_add_u32 v5, s36, v3
v_mul_f32 v17, v17, v18
ds_write_b32 v5, v17 offset:2080
s_setpc_b64 s[58:59]
L_evx:
s_sub_u32 s10, s9, 5
L_progx:
ds_read_b32 v10, v14 offset:2048
s_waitcnt lgkmcnt(0)
v_readfirstlane_b32 s37, v10
s_cmp_ge_u32 s37, s9
s_cbranch_scc1 L_progdonex
s_cmp_ge_u32 s37, s10
s_cbranch_scc1 L_progsx
s_sleep 16
L_progsx:
s_sleep 1
s_sub_u32 s64, s64, 1
s_cmp_gt_i32 s64, 0
s_cbranch_scc1 L_progx
L_progdonex:
v_and_b32 v5, 31, v0
v_lshlrev_b32 v5, 5, v5
L_evx1:
buffer_load_dwordx2 v[16:17], v5, s[20:23], s52 offen sc1
s_waitcnt vmcnt(0)
v_cmp_ne_u32 vcc, v15, v17
s_cbranch_vccz L_evx2
s_sleep 8
s_sub_u32 s64, s64, 1
s_cmp_gt_i32 s64, 0
s_cbranch_scc1 L_evx1
s_setpc_b64 s[58:59]
L_evx2:
v_cmp_ne_u32 vcc, s53, v16
s_cbranch_vccnz L_evx3
ds_write_b32 v14, v8 offset:2060
L_evx3:
s_setpc_b64 s[58:59]
L_hdone:
L_end:
s_endpgm
L_stream:
s_sub_u32 s33, s33, 1
s_and_b32 s36, s2, 7
s_lshr_b32 s37, s2, 4
s_lshl_b32 s37, s37, 3
s_add_u32 s36, s36, s37
s_lshl_b32 s36, s36, 20
s_bfe_u32 s37, s2, 0x10003
s_lshl_b32 s37, s37, 16
s_add_u32 s36, s36, s37
v_lshrrev_b32 v5, 5, v0
v_lshlrev_b32 v8, 7, v5
v_bfe_u32 v5, v0, 4, 1
v_lshl_add_u32 v8, v5, 5, v8
v_bfe_u32 v5, v0, 2, 2
v_lshl_add_u32 v196, v5, 8, v8
v_bfe_u32 v5, v0, 1, 1
v_lshl_add_u32 v196, v5, 6, v196
v_lshlrev_b32 v197, 10, v5
v_and_b32 v5, 1, v0
v_lshl_add_u32 v196, v5, 4, v196
s_mov_b32 s14, 0xf0000
s_mov_b32 s15, 0x20000
s_waitcnt lgkmcnt(0)
s_add_u32 s12, s4, s36
s_addc_u32 s13, s5, 0
s_add_u32 s6, s6, s36
s_addc_u32 s7, s7, 0
s_add_u32 s8, s8, s36
s_addc_u32 s9, s9, 0
s_add_u32 s10, s10, s36
s_addc_u32 s11, s11, 0
v_mov_b32 v1, v197
s_barrier
s_add_u32 s3, s33, 0
s_bfe_u32 s39, s3, 0x30003
s_lshl_b32 s39, s39, 17
s_and_b32 s38, s3, 7
s_lshl_b32 s38, s38, 13
s_add_u32 s39, s39, s38
v_add_u32 v2, s39, v196
v_add_u32 v3, 0x1000, v2
buffer_load_dwordx4 v[208:211], v2, s[12:15], 0 offen offset:0 nt
buffer_load_dwordx4 v[212:215], v2, s[12:15], 0 offen offset:1024 nt
buffer_load_dwordx4 v[216:219], v2, s[12:15], 0 offen offset:2048 nt
buffer_load_dwordx4 v[220:223], v2, s[12:15], 0 offen offset:3072 nt
buffer_load_dwordx4 v[224:227], v3, s[12:15], 0 offen offset:0 nt
buffer_load_dwordx4 v[228:231], v3, s[12:15], 0 offen offset:1024 nt
buffer_load_dwordx4 v[232:235], v3, s[12:15], 0 offen offset:2048 nt
buffer_load_dwordx4 v[236:239], v3, s[12:15], 0 offen offset:3072 nt
s_mov_b32 s24, s46
s_mov_b32 s25, s47
s_mov_b32 s26, 0x400000
s_mov_b32 s27, 0x20000
s_mov_b32 s42, 0x3e0293ee
v_mov_b32 v56, 0xff61b1e6
v_mov_b32 v57, 0xfde63d83
v_mov_b32 v58, 0
v_mov_b32 v63, 0
v_mov_b32 v242, 1
v_mov_b32 v60, 0
v_mov_b32 v61, 0
v_lshlrev_b32 v241, 4, v0
v_mov_b32 v198, v241
v_and_b32 v10, 3, v0
v_lshrrev_b32 v9, 4, v0
v_lshl_add_u32 v250, v10, 8, v8
v_bfe_u32 v11, v0, 3, 1
v_lshl_add_u32 v250, v11, 6, v250
v_cmp_eq_u32 s[96:97], 1, v11
v_bfe_u32 v11, v0, 2, 1
v_lshl_add_u32 v250, v11, 4, v250
v_cmp_eq_u32 s[94:95], 1, v11
v_lshlrev_b32 v199, 10, v11
v_lshlrev_b32 v249, 5, v10
v_lshl_add_u32 v249, v9, 7, v249
v_add_u32 v249, 23552, v249
v_mul_u32_u24 v254, 544, v10
v_lshl_add_u32 v254, v9, 7, v254
v_bfe_u32 v11, v0, 2, 2
v_lshl_add_u32 v254, v11, 3, v254
s_mul_i32 s36, s33, 2176
v_add_u32 v254, s36, v254
v_cmp_eq_u32 vcc, 0, v11
s_nop 1
v_cndmask_b32 v204, 0, -1, vcc
v_cmp_eq_u32 vcc, 1, v11
s_nop 1
v_cndmask_b32 v205, 0, -1, vcc
v_cmp_eq_u32 vcc, 2, v11
s_nop 1
v_cndmask_b32 v206, 0, -1, vcc
v_cmp_eq_u32 vcc, 3, v11
s_nop 1
v_cndmask_b32 v207, 0, -1, vcc
v_and_b32 v10, 12, v0
v_cmp_eq_u32 s[18:19], 0, v10
v_mov_b32 v246, s40
v_mov_b32 v247, s41
v_mov_b32 v10, 0x01000504
v_mov_b32 v11, 0x03020706
v_cndmask_b32 v246, v246, v10, s[94:95]
v_cndmask_b32 v247, v247, v11, s[94:95]
v_lshlrev_b32 v251, 13, v9
v_and_b32 v9, 15, v0
v_lshl_add_u32 v251, v9, 4, v251
v_lshrrev_b32 v10, 5, v0
v_and_b32 v11, 31, v0
v_mul_u32_u24 v200, 8704, v10
v_lshl_add_u32 v200, v11, 4, v200
s_mul_i32 s36, s33, 544
v_add_u32 v200, s36, v200
s_lshl_b32 s36, s33, 2
v_lshl_add_u32 v201, v10, 4, s36
s_mov_b32 s36, 0x88000
v_mul_lo_u32 v202, v10, s36
v_lshl_add_u32 v202, v11, 4, v202
s_lshr_b32 s29, s2, 5
s_bfe_u32 s58, s2, 0x20003
s_bfe_u32 s59, s2, 0x10002
s_lshl_b32 s59, s59, 1
s_and_b32 s37, s2, 1
s_add_u32 s59, s59, s37
s_lshl_b32 s62, s29, 19
s_lshl_b32 s37, s58, 17
s_add_u32 s62, s62, s37
s_lshl_b32 s37, s33, 15
s_add_u32 s62, s62, s37
s_lshl_b32 s37, s59, 8
s_add_u32 s62, s62, s37
s_add_u32 s63, s62, 4096
s_mul_i32 s39, s33, 512
s_add_u32 s32, s32, s39
s_lshl_b32 s57, s28, 3
s_add_u32 s57, s57, s29
s_mul_i32 s57, s57, 69632
s_mul_i32 s39, s58, 512
s_add_u32 s57, s57, s39
s_add_u32 s57, s57, 0x200000
s_mov_b32 s60, 0
s_mov_b32 s50, 0
s_mov_b32 s51, 0
s_mov_b32 s56, 5
s_add_u32 s52, s33, 4
s_bfe_u32 s39, s52, 0x30003
s_lshl_b32 s39, s39, 17
s_and_b32 s38, s52, 7
s_lshl_b32 s38, s38, 13
s_add_u32 s39, s39, s38
s_waitcnt vmcnt(2)
v_add_u32 v2, s39, v196
v_add_u32 v3, 1024, v2
v_add_u32 v2, v2, v1
v_sub_u32 v3, v3, v1
v_add_u32 v4, 0x1000, v2
v_add_u32 v5, 0x1000, v3
buffer_load_dwordx4 v[64:67], v2, s[12:15], 0 offen offset:0 nt
buffer_load_dwordx4 v[68:71], v3, s[12:15], 0 offen offset:0 nt
buffer_load_dwordx4 v[72:75], v2, s[12:15], 0 offen offset:2048 nt
buffer_load_dwordx4 v[76:79], v3, s[12:15], 0 offen offset:2048 nt
buffer_load_dwordx4 v[80:83], v4, s[12:15], 0 offen offset:0 nt
buffer_load_dwordx4 v[84:87], v5, s[12:15], 0 offen offset:0 nt
buffer_load_dwordx4 v[88:91], v4, s[12:15], 0 offen offset:2048 nt
buffer_load_dwordx4 v[92:95], v5, s[12:15], 0 offen offset:2048 nt
s_add_u32 s53, s33, 8
s_bfe_u32 s39, s53, 0x30003
s_lshl_b32 s39, s39, 17
s_and_b32 s38, s53, 7
s_lshl_b32 s38, s38, 13
s_add_u32 s39, s39, s38
s_waitcnt vmcnt(2)
v_add_u32 v2, s39, v196
v_add_u32 v3, 0x1000, v2
buffer_load_dwordx4 v[96:99], v2, s[12:15], 0 offen offset:0 nt
buffer_load_dwordx4 v[100:103], v2, s[12:15], 0 offen offset:1024 nt
buffer_load_dwordx4 v[104:107], v2, s[12:15], 0 offen offset:2048 nt
buffer_load_dwordx4 v[108:111], v2, s[12:15], 0 offen offset:3072 nt
buffer_load_dwordx4 v[112:115], v3, s[12:15], 0 offen offset:0 nt
buffer_load_dwordx4 v[116:119], v3, s[12:15], 0 offen offset:1024 nt
buffer_load_dwordx4 v[120:123], v3, s[12:15], 0 offen offset:2048 nt
buffer_load_dwordx4 v[124:127], v3, s[12:15], 0 offen offset:3072 nt
s_add_u32 s54, s33, 12
s_bfe_u32 s39, s54, 0x30003
s_lshl_b32 s39, s39, 17
s_and_b32 s38, s54, 7
s_lshl_b32 s38, s38, 13
s_add_u32 s39, s39, s38
s_waitcnt vmcnt(2)
v_add_u32 v2, s39, v196
v_add_u32 v3, 1024, v2
v_add_u32 v2, v2, v1
v_sub_u32 v3, v3, v1
v_add_u32 v4, 0x1000, v2
v_add_u32 v5, 0x1000, v3
buffer_load_dwordx4 v[128:131], v2, s[12:15], 0 offen offset:0 nt
buffer_load_dwordx4 v[132:135], v3, s[12:15], 0 offen offset:0 nt
buffer_load_dwordx4 v[136:139], v2, s[12:15], 0 offen offset:2048 nt
buffer_load_dwordx4 v[140:143], v3, s[12:15], 0 offen offset:2048 nt
buffer_load_dwordx4 v[144:147], v4, s[12:15], 0 offen offset:0 nt
buffer_load_dwordx4 v[148:151], v5, s[12:15], 0 offen offset:0 nt
buffer_load_dwordx4 v[152:155], v4, s[12:15], 0 offen offset:2048 nt
buffer_load_dwordx4 v[156:159], v5, s[12:15], 0 offen offset:2048 nt
s_add_u32 s55, s33, 16
s_bfe_u32 s39, s55, 0x30003
s_lshl_b32 s39, s39, 17
s_and_b32 s38, s55, 7
s_lshl_b32 s38, s38, 13
s_add_u32 s39, s39, s38
s_waitcnt vmcnt(2)
v_add_u32 v2, s39, v196
v_add_u32 v3, 0x1000, v2
buffer_load_dwordx4 v[160:163], v2, s[12:15], 0 offen offset:0 nt
buffer_load_dwordx4 v[164:167], v2, s[12:15], 0 offen offset:1024 nt
buffer_load_dwordx4 v[168:171], v2, s[12:15], 0 offen offset:2048 nt
buffer_load_dwordx4 v[172:175], v2, s[12:15], 0 offen offset:3072 nt
buffer_load_dwordx4 v[176:179], v3, s[12:15], 0 offen offset:0 nt
buffer_load_dwordx4 v[180:183], v3, s[12:15], 0 offen offset:1024 nt
buffer_load_dwordx4 v[184:187], v3, s[12:15], 0 offen offset:2048 nt
buffer_load_dwordx4 v[188:191], v3, s[12:15], 0 offen offset:3072 nt
L_qa:
ds_read_b32 v9, v63 offset:2064
s_waitcnt lgkmcnt(0)
v_readfirstlane_b32 s37, v9
s_cmp_lg_u32 s37, 0
s_cbranch_scc1 L_qaok
s_sleep 1
s_sub_u32 s64, s64, 1
s_cmp_gt_i32 s64, 0
s_cbranch_scc1 L_qa
L_qaok:
ds_read_b128 v[192:195], v250 offset:0
ds_read_b32 v62, v63 offset:2052
s_lshl_b32 s38, s33, 9
v_add_u32 v7, s38, v249
s_waitcnt lgkmcnt(0)
v_mfma_f32_16x16x32_bf16 v[24:27], v[208:211], v[192:195], 0
v_mfma_f32_16x16x32_bf16 v[28:31], v[212:215], v[192:195], 0
v_mfma_f32_16x16x32_bf16 v[32:35], v[216:219], v[192:195], 0
v_mfma_f32_16x16x32_bf16 v[36:39], v[220:223], v[192:195], 0
v_mfma_f32_16x16x32_bf16 v[40:43], v[224:227], v[192:195], 0
v_mfma_f32_16x16x32_bf16 v[44:47], v[228:231], v[192:195], 0
v_mfma_f32_16x16x32_bf16 v[48:51], v[232:235], v[192:195], 0
v_mfma_f32_16x16x32_bf16 v[52:55], v[236:239], v[192:195], 0
s_nop 0
v_cndmask_b32 v8, v24, v25, s[94:95]
v_cndmask_b32 v16, v26, v27, s[94:95]
v_cndmask_b32 v9, v28, v29, s[94:95]
v_cndmask_b32 v17, v30, v31, s[94:95]
v_cndmask_b32 v10, v32, v33, s[94:95]
v_cndmask_b32 v18, v34, v35, s[94:95]
v_cndmask_b32 v11, v36, v37, s[94:95]
v_cndmask_b32 v19, v38, v39, s[94:95]
v_cndmask_b32 v12, v40, v41, s[94:95]
v_cndmask_b32 v20, v42, v43, s[94:95]
v_cndmask_b32 v13, v44, v45, s[94:95]
v_cndmask_b32 v21, v46, v47, s[94:95]
v_cndmask_b32 v14, v48, v49, s[94:95]
v_cndmask_b32 v22, v50, v51, s[94:95]
v_cndmask_b32 v15, v52, v53, s[94:95]
v_cndmask_b32 v23, v54, v55, s[94:95]
v_cndmask_b32 v8, v8, v16, s[96:97]
v_cndmask_b32 v9, v9, v17, s[96:97]
v_cndmask_b32 v10, v10, v18, s[96:97]
v_cndmask_b32 v11, v11, v19, s[96:97]
v_cndmask_b32 v12, v12, v20, s[96:97]
v_cndmask_b32 v13, v13, v21, s[96:97]
v_cndmask_b32 v14, v14, v22, s[96:97]
v_cndmask_b32 v15, v15, v23, s[96:97]
v_add_f32_dpp v8, v8, v8 row_ror:4 row_mask:0xf bank_mask:0xf
v_add_f32_dpp v9, v9, v9 row_ror:4 row_mask:0xf bank_mask:0xf
v_add_f32_dpp v10, v10, v10 row_ror:4 row_mask:0xf bank_mask:0xf
v_add_f32_dpp v11, v11, v11 row_ror:4 row_mask:0xf bank_mask:0xf
v_add_f32_dpp v12, v12, v12 row_ror:4 row_mask:0xf bank_mask:0xf
v_add_f32_dpp v13, v13, v13 row_ror:4 row_mask:0xf bank_mask:0xf
v_add_f32_dpp v14, v14, v14 row_ror:4 row_mask:0xf bank_mask:0xf
v_add_f32_dpp v15, v15, v15 row_ror:4 row_mask:0xf bank_mask:0xf
v_add_f32_dpp v8, v8, v8 row_ror:8 row_mask:0xf bank_mask:0xf
v_add_f32_dpp v9, v9, v9 row_ror:8 row_mask:0xf bank_mask:0xf
v_add_f32_dpp v10, v10, v10 row_ror:8 row_mask:0xf bank_mask:0xf
v_add_f32_dpp v11, v11, v11 row_ror:8 row_mask:0xf bank_mask:0xf
v_add_f32_dpp v12, v12, v12 row_ror:8 row_mask:0xf bank_mask:0xf
v_add_f32_dpp v13, v13, v13 row_ror:8 row_mask:0xf bank_mask:0xf
v_add_f32_dpp v14, v14, v14 row_ror:8 row_mask:0xf bank_mask:0xf
v_add_f32_dpp v15, v15, v15 row_ror:8 row_mask:0xf bank_mask:0xf
s_mov_b64 exec, s[18:19]
ds_write_b128 v7, v[8:11]
ds_write_b128 v7, v[12:15] offset:16
s_mov_b64 exec, -1
v_max3_f32 v56, v56, v8, v9
v_max3_f32 v59, v10, v11, v12
v_max3_f32 v56, v56, v13, v14
v_max3_f32 v56, v56, v59, v15
v_mul_f32 v59, s42, v56
v_sub_f32 v6, v57, v59
v_mov_b32 v57, v59
v_exp_f32 v6, v6
v_fma_f32 v16, v8, s42, -v57
v_fma_f32 v17, v9, s42, -v57
v_fma_f32 v18, v10, s42, -v57
v_fma_f32 v19, v11, s42, -v57
v_fma_f32 v20, v12, s42, -v57
v_fma_f32 v21, v13, s42, -v57
v_fma_f32 v22, v14, s42, -v57
v_fma_f32 v23, v15, s42, -v57
v_exp_f32 v16, v16
v_exp_f32 v17, v17
v_exp_f32 v18, v18
v_exp_f32 v19, v19
v_exp_f32 v20, v20
v_exp_f32 v21, v21
v_exp_f32 v22, v22
v_exp_f32 v23, v23
v_fma_f32 v58, v58, v6, v16
v_add_f32 v17, v17, v18
v_add_f32 v19, v19, v20
v_add_f32 v21, v21, v22
v_add_f32 v58, v58, v23
v_add_f32 v17, v17, v19
v_add_f32 v58, v58, v21
v_add_f32 v58, v58, v17
s_branch L_body0
L_trans:
s_bitcmp1_b32 s50, 0
s_cbranch_scc1 L_tr_v
v_mov_b32 v6, v56
s_nop 1
v_permlane32_swap_b32 v56, v6
v_max_f32 v56, v56, v6
v_mov_b32 v6, v56
s_nop 1
v_permlane16_swap_b32 v56, v6
v_max_f32 v56, v56, v6
v_mul_f32 v59, s42, v56
v_sub_f32 v59, v57, v59
v_min_f32 v59, 0, v59
v_exp_f32 v59, v59
s_nop 0
v_mul_f32 v58, v58, v59
v_mov_b32 v6, v58
s_nop 1
v_permlane32_swap_b32 v58, v6
v_add_f32 v58, v58, v6
v_mov_b32 v6, v58
s_nop 1
v_permlane16_swap_b32 v58, v6
v_add_f32 v58, v58, v6
s_lshl_b32 s36, s50, 5
v_and_b32 v9, 3, v0
v_lshl_add_u32 v9, v9, 2, s36
s_lshl_b32 s37, s33, 4
v_add_u32 v10, s37, v9
ds_write_b32 v10, v56 offset:2112
ds_write_b32 v10, v58 offset:2240
s_lshl_b32 s36, s50, 1
v_mov_b32 v10, s36
s_mov_b64 exec, 1
ds_add_u32 v10, v242 offset:2072
s_mov_b64 exec, -1
v_mov_b32 v24, 0
v_mov_b32 v25, 0
v_mov_b32 v26, 0
v_mov_b32 v27, 0
v_mov_b32 v28, 0
v_mov_b32 v29, 0
v_mov_b32 v30, 0
v_mov_b32 v31, 0
L_tr_w:
ds_read_b32 v11, v10 offset:2072
s_waitcnt lgkmcnt(0)
v_readfirstlane_b32 s37, v11
s_cmp_ge_u32 s37, 4
s_cbranch_scc1 L_tr_k2
s_sub_u32 s64, s64, 1
s_cmp_gt_i32 s64, 0
s_cbranch_scc1 L_tr_w
L_tr_k2:
v_add_u32 v9, 2112, v9
ds_read2_b32 v[12:13], v9 offset0:0 offset1:4
ds_read2_b32 v[14:15], v9 offset0:8 offset1:12
s_waitcnt lgkmcnt(0)
v_max3_f32 v12, v12, v13, v14
v_max_f32 v12, v12, v15
v_mul_f32 v57, s42, v12
s_branch L_tr_n
L_tr_v:
s_lshr_b32 s36, s50, 1
s_mul_i32 s37, s36, 8704
s_add_u32 s37, s37, 6144
v_add_u32 v9, s37, v254
ds_write2_b32 v9, v24, v28 offset0:0 offset1:1
ds_write2_b32 v9, v25, v29 offset0:8 offset1:9
ds_write2_b32 v9, v26, v30 offset0:16 offset1:17
ds_write2_b32 v9, v27, v31 offset0:24 offset1:25
s_cmp_eq_u32 s50, 3
s_cbranch_scc1 L_tr_n
v_mov_b32 v56, 0xff61b1e6
v_mov_b32 v57, 0xfde63d83
v_mov_b32 v58, 0
L_qb:
ds_read_b32 v9, v63 offset:2068
s_waitcnt lgkmcnt(0)
v_readfirstlane_b32 s37, v9
s_cmp_lg_u32 s37, 0
s_cbranch_scc1 L_qbok
s_sleep 1
s_sub_u32 s64, s64, 1
s_cmp_gt_i32 s64, 0
s_cbranch_scc1 L_qb
L_qbok:
ds_read_b128 v[192:195], v250 offset:1024
s_waitcnt lgkmcnt(0)
L_tr_n:
s_add_u32 s50, s50, 1
s_cmp_lt_u32 s50, s65
s_cbranch_scc1 L_trans
s_setpc_b64 s[16:17]
L_tcall0:
s_call_b64 s[16:17], L_trans
s_branch L_tok0
L_ldph0:
s_mov_b64 s[12:13], s[6:7]
s_mov_b64 s[6:7], s[8:9]
s_mov_b64 s[8:9], s[10:11]
v_swap_b32 v196, v198
v_swap_b32 v197, v199
s_add_u32 s51, s51, 1
s_cmp_lt_u32 s51, s36
s_cbranch_scc1 L_ldph0
s_branch L_ldok0
L_ewk0:
s_waitcnt vmcnt(0)
s_branch L_kgo0
L_ewv0:
s_waitcnt vmcnt(16)
s_cmp_eq_u32 s60, 1
s_cbranch_scc1 L_vgo0
s_waitcnt vmcnt(8)
s_cmp_eq_u32 s60, 2
s_cbranch_scc1 L_vgo0
s_waitcnt vmcnt(0)
s_branch L_vgo0
L_endstep0:
s_add_u32 s60, s60, 1
s_cmp_eq_u32 s60, 4
s_cbranch_scc1 L_exit
s_branch L_body1
L_k0:
s_cmp_lg_u32 s60, 0
s_cbranch_scc1 L_ewk0
s_waitcnt vmcnt(24)
L_kgo0:
v_mfma_f32_16x16x32_bf16 v[24:27], v[64:67], v[192:195], 0
v_mfma_f32_16x16x32_bf16 v[28:31], v[68:71], v[192:195], 0
v_mfma_f32_16x16x32_bf16 v[32:35], v[72:75], v[192:195], 0
v_mfma_f32_16x16x32_bf16 v[36:39], v[76:79], v[192:195], 0
v_mfma_f32_16x16x32_bf16 v[40:43], v[80:83], v[192:195], 0
v_mfma_f32_16x16x32_bf16 v[44:47], v[84:87], v[192:195], 0
v_mfma_f32_16x16x32_bf16 v[48:51], v[88:91], v[192:195], 0
v_mfma_f32_16x16x32_bf16 v[52:55], v[92:95], v[192:195], 0
s_nop 0
v_cndmask_b32 v8, v24, v25, s[94:95]
v_cndmask_b32 v16, v26, v27, s[94:95]
v_cndmask_b32 v9, v28, v29, s[94:95]
v_cndmask_b32 v17, v30, v31, s[94:95]
v_cndmask_b32 v10, v32, v33, s[94:95]
v_cndmask_b32 v18, v34, v35, s[94:95]
v_cndmask_b32 v11, v36, v37, s[94:95]
v_cndmask_b32 v19, v38, v39, s[94:95]
v_cndmask_b32 v12, v40, v41, s[94:95]
v_cndmask_b32 v20, v42, v43, s[94:95]
v_cndmask_b32 v13, v44, v45, s[94:95]
v_cndmask_b32 v21, v46, v47, s[94:95]
v_cndmask_b32 v14, v48, v49, s[94:95]
v_cndmask_b32 v22, v50, v51, s[94:95]
v_cndmask_b32 v15, v52, v53, s[94:95]
v_cndmask_b32 v23, v54, v55, s[94:95]
s_bitcmp1_b32 s56, 0
s_cbranch_scc1 L_kx0
v_cndmask_b32 v8, v8, v16, s[96:97]
v_cndmask_b32 v9, v9, v17, s[96:97]
v_cndmask_b32 v10, v10, v18, s[96:97]
v_cndmask_b32 v11, v11, v19, s[96:97]
v_cndmask_b32 v12, v12, v20, s[96:97]
v_cndmask_b32 v13, v13, v21, s[96:97]
v_cndmask_b32 v14, v14, v22, s[96:97]
v_cndmask_b32 v15, v15, v23, s[96:97]
s_branch L_ky0
L_kx0:
v_cndmask_b32 v8, v8, v17, s[96:97]
v_cndmask_b32 v9, v9, v16, s[96:97]
v_cndmask_b32 v10, v10, v19, s[96:97]
v_cndmask_b32 v11, v11, v18, s[96:97]
v_cndmask_b32 v12, v12, v21, s[96:97]
v_cndmask_b32 v13, v13, v20, s[96:97]
v_cndmask_b32 v14, v14, v23, s[96:97]
v_cndmask_b32 v15, v15, v22, s[96:97]
L_ky0:
v_add_f32_dpp v8, v8, v8 row_ror:4 row_mask:0xf bank_mask:0xf
v_add_f32_dpp v9, v9, v9 row_ror:4 row_mask:0xf bank_mask:0xf
v_add_f32_dpp v10, v10, v10 row_ror:4 row_mask:0xf bank_mask:0xf
v_add_f32_dpp v11, v11, v11 row_ror:4 row_mask:0xf bank_mask:0xf
v_add_f32_dpp v12, v12, v12 row_ror:4 row_mask:0xf bank_mask:0xf
v_add_f32_dpp v13, v13, v13 row_ror:4 row_mask:0xf bank_mask:0xf
v_add_f32_dpp v14, v14, v14 row_ror:4 row_mask:0xf bank_mask:0xf
v_add_f32_dpp v15, v15, v15 row_ror:4 row_mask:0xf bank_mask:0xf
v_add_f32_dpp v8, v8, v8 row_ror:8 row_mask:0xf bank_mask:0xf
v_add_f32_dpp v9, v9, v9 row_ror:8 row_mask:0xf bank_mask:0xf
v_add_f32_dpp v10, v10, v10 row_ror:8 row_mask:0xf bank_mask:0xf
v_add_f32_dpp v11, v11, v11 row_ror:8 row_mask:0xf bank_mask:0xf
v_add_f32_dpp v12, v12, v12 row_ror:8 row_mask:0xf bank_mask:0xf
v_add_f32_dpp v13, v13, v13 row_ror:8 row_mask:0xf bank_mask:0xf
v_add_f32_dpp v14, v14, v14 row_ror:8 row_mask:0xf bank_mask:0xf
v_add_f32_dpp v15, v15, v15 row_ror:8 row_mask:0xf bank_mask:0xf
s_mov_b64 exec, s[18:19]
ds_write_b128 v7, v[8:11]
ds_write_b128 v7, v[12:15] offset:16
s_mov_b64 exec, -1
v_max3_f32 v56, v56, v8, v9
v_max3_f32 v59, v10, v11, v12
v_max3_f32 v56, v56, v13, v14
v_max3_f32 v56, v56, v59, v15
v_mul_f32 v59, s42, v56
v_sub_f32 v6, v57, v59
v_mov_b32 v57, v59
v_exp_f32 v6, v6
v_fma_f32 v16, v8, s42, -v57
v_fma_f32 v17, v9, s42, -v57
v_fma_f32 v18, v10, s42, -v57
v_fma_f32 v19, v11, s42, -v57
v_fma_f32 v20, v12, s42, -v57
v_fma_f32 v21, v13, s42, -v57
v_fma_f32 v22, v14, s42, -v57
v_fma_f32 v23, v15, s42, -v57
v_exp_f32 v16, v16
v_exp_f32 v17, v17
v_exp_f32 v18, v18
v_exp_f32 v19, v19
v_exp_f32 v20, v20
v_exp_f32 v21, v21
v_exp_f32 v22, v22
v_exp_f32 v23, v23
v_fma_f32 v58, v58, v6, v16
v_add_f32 v17, v17, v18
v_add_f32 v19, v19, v20
v_add_f32 v21, v21, v22
v_add_f32 v58, v58, v23
v_add_f32 v17, v17, v19
v_add_f32 v58, v58, v21
v_add_f32 v58, v58, v17
s_branch L_refill0
L_tcall1:
s_call_b64 s[16:17], L_trans
s_branch L_tok1
L_ldph1:
s_mov_b64 s[12:13], s[6:7]
s_mov_b64 s[6:7], s[8:9]
s_mov_b64 s[8:9], s[10:11]
v_swap_b32 v196, v198
v_swap_b32 v197, v199
s_add_u32 s51, s51, 1
s_cmp_lt_u32 s51, s36
s_cbranch_scc1 L_ldph1
s_branch L_ldok1
L_ewk1:
s_waitcnt vmcnt(0)
s_branch L_kgo1
L_ewv1:
s_waitcnt vmcnt(16)
s_cmp_eq_u32 s60, 1
s_cbranch_scc1 L_vgo1
s_waitcnt vmcnt(8)
s_cmp_eq_u32 s60, 2
s_cbranch_scc1 L_vgo1
s_waitcnt vmcnt(0)
s_branch L_vgo1
L_endstep1:
s_add_u32 s60, s60, 1
s_cmp_eq_u32 s60, 4
s_cbranch_scc1 L_exit
s_branch L_body2
L_k1:
s_cmp_lg_u32 s60, 0
s_cbranch_scc1 L_ewk1
s_waitcnt vmcnt(24)
L_kgo1:
v_mfma_f32_16x16x32_bf16 v[24:27], v[96:99], v[192:195], 0
v_mfma_f32_16x16x32_bf16 v[28:31], v[100:103], v[192:195], 0
v_mfma_f32_16x16x32_bf16 v[32:35], v[104:107], v[192:195], 0
v_mfma_f32_16x16x32_bf16 v[36:39], v[108:111], v[192:195], 0
v_mfma_f32_16x16x32_bf16 v[40:43], v[112:115], v[192:195], 0
v_mfma_f32_16x16x32_bf16 v[44:47], v[116:119], v[192:195], 0
v_mfma_f32_16x16x32_bf16 v[48:51], v[120:123], v[192:195], 0
v_mfma_f32_16x16x32_bf16 v[52:55], v[124:127], v[192:195], 0
s_nop 0
v_cndmask_b32 v8, v24, v25, s[94:95]
v_cndmask_b32 v16, v26, v27, s[94:95]
v_cndmask_b32 v9, v28, v29, s[94:95]
v_cndmask_b32 v17, v30, v31, s[94:95]
v_cndmask_b32 v10, v32, v33, s[94:95]
v_cndmask_b32 v18, v34, v35, s[94:95]
v_cndmask_b32 v11, v36, v37, s[94:95]
v_cndmask_b32 v19, v38, v39, s[94:95]
v_cndmask_b32 v12, v40, v41, s[94:95]
v_cndmask_b32 v20, v42, v43, s[94:95]
v_cndmask_b32 v13, v44, v45, s[94:95]
v_cndmask_b32 v21, v46, v47, s[94:95]
v_cndmask_b32 v14, v48, v49, s[94:95]
v_cndmask_b32 v22, v50, v51, s[94:95]
v_cndmask_b32 v15, v52, v53, s[94:95]
v_cndmask_b32 v23, v54, v55, s[94:95]
v_cndmask_b32 v8, v8, v16, s[96:97]
v_cndmask_b32 v9, v9, v17, s[96:97]
v_cndmask_b32 v10, v10, v18, s[96:97]
v_cndmask_b32 v11, v11, v19, s[96:97]
v_cndmask_b32 v12, v12, v20, s[96:97]
v_cndmask_b32 v13, v13, v21, s[96:97]
v_cndmask_b32 v14, v14, v22, s[96:97]
v_cndmask_b32 v15, v15, v23, s[96:97]
v_add_f32_dpp v8, v8, v8 row_ror:4 row_mask:0xf bank_mask:0xf
v_add_f32_dpp v9, v9, v9 row_ror:4 row_mask:0xf bank_mask:0xf
v_add_f32_dpp v10, v10, v10 row_ror:4 row_mask:0xf bank_mask:0xf
v_add_f32_dpp v11, v11, v11 row_ror:4 row_mask:0xf bank_mask:0xf
v_add_f32_dpp v12, v12, v12 row_ror:4 row_mask:0xf bank_mask:0xf
v_add_f32_dpp v13, v13, v13 row_ror:4 row_mask:0xf bank_mask:0xf
v_add_f32_dpp v14, v14, v14 row_ror:4 row_mask:0xf bank_mask:0xf
v_add_f32_dpp v15, v15, v15 row_ror:4 row_mask:0xf bank_mask:0xf
v_add_f32_dpp v8, v8, v8 row_ror:8 row_mask:0xf bank_mask:0xf
v_add_f32_dpp v9, v9, v9 row_ror:8 row_mask:0xf bank_mask:0xf
v_add_f32_dpp v10, v10, v10 row_ror:8 row_mask:0xf bank_mask:0xf
v_add_f32_dpp v11, v11, v11 row_ror:8 row_mask:0xf bank_mask:0xf
v_add_f32_dpp v12, v12, v12 row_ror:8 row_mask:0xf bank_mask:0xf
v_add_f32_dpp v13, v13, v13 row_ror:8 row_mask:0xf bank_mask:0xf
v_add_f32_dpp v14, v14, v14 row_ror:8 row_mask:0xf bank_mask:0xf
v_add_f32_dpp v15, v15, v15 row_ror:8 row_mask:0xf bank_mask:0xf
s_mov_b64 exec, s[18:19]
ds_write_b128 v7, v[8:11]
ds_write_b128 v7, v[12:15] offset:16
s_mov_b64 exec, -1
v_max3_f32 v56, v56, v8, v9
v_max3_f32 v59, v10, v11, v12
v_max3_f32 v56, v56, v13, v14
v_max3_f32 v56, v56, v59, v15
v_mul_f32 v59, s42, v56
v_sub_f32 v6, v57, v59
v_mov_b32 v57, v59
v_exp_f32 v6, v6
v_fma_f32 v16, v8, s42, -v57
v_fma_f32 v17, v9, s42, -v57
v_fma_f32 v18, v10, s42, -v57
v_fma_f32 v19, v11, s42, -v57
v_fma_f32 v20, v12, s42, -v57
v_fma_f32 v21, v13, s42, -v57
v_fma_f32 v22, v14, s42, -v57
v_fma_f32 v23, v15, s42, -v57
v_exp_f32 v16, v16
v_exp_f32 v17, v17
v_exp_f32 v18, v18
v_exp_f32 v19, v19
v_exp_f32 v20, v20
v_exp_f32 v21, v21
v_exp_f32 v22, v22
v_exp_f32 v23, v23
v_fma_f32 v58, v58, v6, v16
v_add_f32 v17, v17, v18
v_add_f32 v19, v19, v20
v_add_f32 v21, v21, v22
v_add_f32 v58, v58, v23
v_add_f32 v17, v17, v19
v_add_f32 v58, v58, v21
v_add_f32 v58, v58, v17
s_branch L_refill1
L_tcall2:
s_call_b64 s[16:17], L_trans
s_branch L_tok2
L_ldph2:
s_mov_b64 s[12:13], s[6:7]
s_mov_b64 s[6:7], s[8:9]
s_mov_b64 s[8:9], s[10:11]
v_swap_b32 v196, v198
v_swap_b32 v197, v199
s_add_u32 s51, s51, 1
s_cmp_lt_u32 s51, s36
s_cbranch_scc1 L_ldph2
s_branch L_ldok2
L_ewk2:
s_waitcnt vmcnt(0)
s_branch L_kgo2
L_ewv2:
s_waitcnt vmcnt(16)
s_cmp_eq_u32 s60, 1
s_cbranch_scc1 L_vgo2
s_waitcnt vmcnt(8)
s_cmp_eq_u32 s60, 2
s_cbranch_scc1 L_vgo2
s_waitcnt vmcnt(0)
s_branch L_vgo2
L_endstep2:
s_add_u32 s60, s60, 1
s_cmp_eq_u32 s60, 4
s_cbranch_scc1 L_exit
s_branch L_body3
L_k2:
s_cmp_lg_u32 s60, 0
s_cbranch_scc1 L_ewk2
s_waitcnt vmcnt(24)
L_kgo2:
v_mfma_f32_16x16x32_bf16 v[24:27], v[128:131], v[192:195], 0
v_mfma_f32_16x16x32_bf16 v[28:31], v[132:135], v[192:195], 0
v_mfma_f32_16x16x32_bf16 v[32:35], v[136:139], v[192:195], 0
v_mfma_f32_16x16x32_bf16 v[36:39], v[140:143], v[192:195], 0
v_mfma_f32_16x16x32_bf16 v[40:43], v[144:147], v[192:195], 0
v_mfma_f32_16x16x32_bf16 v[44:47], v[148:151], v[192:195], 0
v_mfma_f32_16x16x32_bf16 v[48:51], v[152:155], v[192:195], 0
v_mfma_f32_16x16x32_bf16 v[52:55], v[156:159], v[192:195], 0
s_nop 0
v_cndmask_b32 v8, v24, v25, s[94:95]
v_cndmask_b32 v16, v26, v27, s[94:95]
v_cndmask_b32 v9, v28, v29, s[94:95]
v_cndmask_b32 v17, v30, v31, s[94:95]
v_cndmask_b32 v10, v32, v33, s[94:95]
v_cndmask_b32 v18, v34, v35, s[94:95]
v_cndmask_b32 v11, v36, v37, s[94:95]
v_cndmask_b32 v19, v38, v39, s[94:95]
v_cndmask_b32 v12, v40, v41, s[94:95]
v_cndmask_b32 v20, v42, v43, s[94:95]
v_cndmask_b32 v13, v44, v45, s[94:95]
v_cndmask_b32 v21, v46, v47, s[94:95]
v_cndmask_b32 v14, v48, v49, s[94:95]
v_cndmask_b32 v22, v50, v51, s[94:95]
v_cndmask_b32 v15, v52, v53, s[94:95]
v_cndmask_b32 v23, v54, v55, s[94:95]
s_bitcmp1_b32 s56, 2
s_cbranch_scc1 L_kx2
v_cndmask_b32 v8, v8, v16, s[96:97]
v_cndmask_b32 v9, v9, v17, s[96:97]
v_cndmask_b32 v10, v10, v18, s[96:97]
v_cndmask_b32 v11, v11, v19, s[96:97]
v_cndmask_b32 v12, v12, v20, s[96:97]
v_cndmask_b32 v13, v13, v21, s[96:97]
v_cndmask_b32 v14, v14, v22, s[96:97]
v_cndmask_b32 v15, v15, v23, s[96:97]
s_branch L_ky2
L_kx2:
v_cndmask_b32 v8, v8, v17, s[96:97]
v_cndmask_b32 v9, v9, v16, s[96:97]
v_cndmask_b32 v10, v10, v19, s[96:97]
v_cndmask_b32 v11, v11, v18, s[96:97]
v_cndmask_b32 v12, v12, v21, s[96:97]
v_cndmask_b32 v13, v13, v20, s[96:97]
v_cndmask_b32 v14, v14, v23, s[96:97]
v_cndmask_b32 v15, v15, v22, s[96:97]
L_ky2:
v_add_f32_dpp v8, v8, v8 row_ror:4 row_mask:0xf bank_mask:0xf
v_add_f32_dpp v9, v9, v9 row_ror:4 row_mask:0xf bank_mask:0xf
v_add_f32_dpp v10, v10, v10 row_ror:4 row_mask:0xf bank_mask:0xf
v_add_f32_dpp v11, v11, v11 row_ror:4 row_mask:0xf bank_mask:0xf
v_add_f32_dpp v12, v12, v12 row_ror:4 row_mask:0xf bank_mask:0xf
v_add_f32_dpp v13, v13, v13 row_ror:4 row_mask:0xf bank_mask:0xf
v_add_f32_dpp v14, v14, v14 row_ror:4 row_mask:0xf bank_mask:0xf
v_add_f32_dpp v15, v15, v15 row_ror:4 row_mask:0xf bank_mask:0xf
v_add_f32_dpp v8, v8, v8 row_ror:8 row_mask:0xf bank_mask:0xf
v_add_f32_dpp v9, v9, v9 row_ror:8 row_mask:0xf bank_mask:0xf
v_add_f32_dpp v10, v10, v10 row_ror:8 row_mask:0xf bank_mask:0xf
v_add_f32_dpp v11, v11, v11 row_ror:8 row_mask:0xf bank_mask:0xf
v_add_f32_dpp v12, v12, v12 row_ror:8 row_mask:0xf bank_mask:0xf
v_add_f32_dpp v13, v13, v13 row_ror:8 row_mask:0xf bank_mask:0xf
v_add_f32_dpp v14, v14, v14 row_ror:8 row_mask:0xf bank_mask:0xf
v_add_f32_dpp v15, v15, v15 row_ror:8 row_mask:0xf bank_mask:0xf
s_mov_b64 exec, s[18:19]
ds_write_b128 v7, v[8:11]
ds_write_b128 v7, v[12:15] offset:16
s_mov_b64 exec, -1
v_max3_f32 v56, v56, v8, v9
v_max3_f32 v59, v10, v11, v12
v_max3_f32 v56, v56, v13, v14
v_max3_f32 v56, v56, v59, v15
v_mul_f32 v59, s42, v56
v_sub_f32 v6, v57, v59
v_mov_b32 v57, v59
v_exp_f32 v6, v6
v_fma_f32 v16, v8, s42, -v57
v_fma_f32 v17, v9, s42, -v57
v_fma_f32 v18, v10, s42, -v57
v_fma_f32 v19, v11, s42, -v57
v_fma_f32 v20, v12, s42, -v57
v_fma_f32 v21, v13, s42, -v57
v_fma_f32 v22, v14, s42, -v57
v_fma_f32 v23, v15, s42, -v57
v_exp_f32 v16, v16
v_exp_f32 v17, v17
v_exp_f32 v18, v18
v_exp_f32 v19, v19
v_exp_f32 v20, v20
v_exp_f32 v21, v21
v_exp_f32 v22, v22
v_exp_f32 v23, v23
v_fma_f32 v58, v58, v6, v16
v_add_f32 v17, v17, v18
v_add_f32 v19, v19, v20
v_add_f32 v21, v21, v22
v_add_f32 v58, v58, v23
v_add_f32 v17, v17, v19
v_add_f32 v58, v58, v21
v_add_f32 v58, v58, v17
s_branch L_refill2
L_tcall3:
s_call_b64 s[16:17], L_trans
s_branch L_tok3
L_ldph3:
s_mov_b64 s[12:13], s[6:7]
s_mov_b64 s[6:7], s[8:9]
s_mov_b64 s[8:9], s[10:11]
v_swap_b32 v196, v198
v_swap_b32 v197, v199
s_add_u32 s51, s51, 1
s_cmp_lt_u32 s51, s36
s_cbranch_scc1 L_ldph3
s_branch L_ldok3
L_ewk3:
s_waitcnt vmcnt(0)
s_branch L_kgo3
L_ewv3:
s_waitcnt vmcnt(16)
s_cmp_eq_u32 s60, 1
s_cbranch_scc1 L_vgo3
s_waitcnt vmcnt(8)
s_cmp_eq_u32 s60, 2
s_cbranch_scc1 L_vgo3
s_waitcnt vmcnt(0)
s_branch L_vgo3
L_endstep3:
s_add_u32 s60, s60, 1
s_cmp_eq_u32 s60, 4
s_cbranch_scc1 L_exit
s_branch L_body0
L_k3:
s_cmp_lg_u32 s60, 0
s_cbranch_scc1 L_ewk3
s_waitcnt vmcnt(24)
L_kgo3:
v_mfma_f32_16x16x32_bf16 v[24:27], v[160:163], v[192:195], 0
v_mfma_f32_16x16x32_bf16 v[28:31], v[164:167], v[192:195], 0
v_mfma_f32_16x16x32_bf16 v[32:35], v[168:171], v[192:195], 0
v_mfma_f32_16x16x32_bf16 v[36:39], v[172:175], v[192:195], 0
v_mfma_f32_16x16x32_bf16 v[40:43], v[176:179], v[192:195], 0
v_mfma_f32_16x16x32_bf16 v[44:47], v[180:183], v[192:195], 0
v_mfma_f32_16x16x32_bf16 v[48:51], v[184:187], v[192:195], 0
v_mfma_f32_16x16x32_bf16 v[52:55], v[188:191], v[192:195], 0
s_nop 0
v_cndmask_b32 v8, v24, v25, s[94:95]
v_cndmask_b32 v16, v26, v27, s[94:95]
v_cndmask_b32 v9, v28, v29, s[94:95]
v_cndmask_b32 v17, v30, v31, s[94:95]
v_cndmask_b32 v10, v32, v33, s[94:95]
v_cndmask_b32 v18, v34, v35, s[94:95]
v_cndmask_b32 v11, v36, v37, s[94:95]
v_cndmask_b32 v19, v38, v39, s[94:95]
v_cndmask_b32 v12, v40, v41, s[94:95]
v_cndmask_b32 v20, v42, v43, s[94:95]
v_cndmask_b32 v13, v44, v45, s[94:95]
v_cndmask_b32 v21, v46, v47, s[94:95]
v_cndmask_b32 v14, v48, v49, s[94:95]
v_cndmask_b32 v22, v50, v51, s[94:95]
v_cndmask_b32 v15, v52, v53, s[94:95]
v_cndmask_b32 v23, v54, v55, s[94:95]
v_cndmask_b32 v8, v8, v16, s[96:97]
v_cndmask_b32 v9, v9, v17, s[96:97]
v_cndmask_b32 v10, v10, v18, s[96:97]
v_cndmask_b32 v11, v11, v19, s[96:97]
v_cndmask_b32 v12, v12, v20, s[96:97]
v_cndmask_b32 v13, v13, v21, s[96:97]
v_cndmask_b32 v14, v14, v22, s[96:97]
v_cndmask_b32 v15, v15, v23, s[96:97]
v_add_f32_dpp v8, v8, v8 row_ror:4 row_mask:0xf bank_mask:0xf
v_add_f32_dpp v9, v9, v9 row_ror:4 row_mask:0xf bank_mask:0xf
v_add_f32_dpp v10, v10, v10 row_ror:4 row_mask:0xf bank_mask:0xf
v_add_f32_dpp v11, v11, v11 row_ror:4 row_mask:0xf bank_mask:0xf
v_add_f32_dpp v12, v12, v12 row_ror:4 row_mask:0xf bank_mask:0xf
v_add_f32_dpp v13, v13, v13 row_ror:4 row_mask:0xf bank_mask:0xf
v_add_f32_dpp v14, v14, v14 row_ror:4 row_mask:0xf bank_mask:0xf
v_add_f32_dpp v15, v15, v15 row_ror:4 row_mask:0xf bank_mask:0xf
v_add_f32_dpp v8, v8, v8 row_ror:8 row_mask:0xf bank_mask:0xf
v_add_f32_dpp v9, v9, v9 row_ror:8 row_mask:0xf bank_mask:0xf
v_add_f32_dpp v10, v10, v10 row_ror:8 row_mask:0xf bank_mask:0xf
v_add_f32_dpp v11, v11, v11 row_ror:8 row_mask:0xf bank_mask:0xf
v_add_f32_dpp v12, v12, v12 row_ror:8 row_mask:0xf bank_mask:0xf
v_add_f32_dpp v13, v13, v13 row_ror:8 row_mask:0xf bank_mask:0xf
v_add_f32_dpp v14, v14, v14 row_ror:8 row_mask:0xf bank_mask:0xf
v_add_f32_dpp v15, v15, v15 row_ror:8 row_mask:0xf bank_mask:0xf
s_mov_b64 exec, s[18:19]
ds_write_b128 v7, v[8:11]
ds_write_b128 v7, v[12:15] offset:16
s_mov_b64 exec, -1
v_max3_f32 v56, v56, v8, v9
v_max3_f32 v59, v10, v11, v12
v_max3_f32 v56, v56, v13, v14
v_max3_f32 v56, v56, v59, v15
v_mul_f32 v59, s42, v56
v_sub_f32 v6, v57, v59
v_mov_b32 v57, v59
v_exp_f32 v6, v6
v_fma_f32 v16, v8, s42, -v57
v_fma_f32 v17, v9, s42, -v57
v_fma_f32 v18, v10, s42, -v57
v_fma_f32 v19, v11, s42, -v57
v_fma_f32 v20, v12, s42, -v57
v_fma_f32 v21, v13, s42, -v57
v_fma_f32 v22, v14, s42, -v57
v_fma_f32 v23, v15, s42, -v57
v_exp_f32 v16, v16
v_exp_f32 v17, v17
v_exp_f32 v18, v18
v_exp_f32 v19, v19
v_exp_f32 v20, v20
v_exp_f32 v21, v21
v_exp_f32 v22, v22
v_exp_f32 v23, v23
v_fma_f32 v58, v58, v6, v16
v_add_f32 v17, v17, v18
v_add_f32 v19, v19, v20
v_add_f32 v21, v21, v22
v_add_f32 v58, v58, v23
v_add_f32 v17, v17, v19
v_add_f32 v58, v58, v21
v_add_f32 v58, v58, v17
s_branch L_refill3
L_body0:
s_lshr_b32 s65, s52, 6
s_cmp_lg_u32 s65, s50
s_cbranch_scc1 L_tcall0
L_tok0:
s_and_b32 s38, s52, 63
s_lshl_b32 s38, s38, 9
s_lshr_b32 s39, s52, 7
s_lshl_b32 s39, s39, 15
s_add_u32 s38, s38, s39
v_add_u32 v7, s38, v249
s_bitcmp0_b32 s50, 0
s_cbranch_scc1 L_k0
ds_read_b128 v[8:11], v7
ds_read_b128 v[12:15], v7 offset:16
s_bitcmp1_b32 s56, 0
s_cselect_b64 vcc, -1, 0
v_mov_b32 v244, s40
v_mov_b32 v245, s41
v_cndmask_b32 v244, v244, v246, vcc
v_cndmask_b32 v245, v245, v247, vcc
s_waitcnt lgkmcnt(0)
v_fma_f32 v8, v8, s42, -v57
v_fma_f32 v9, v9, s42, -v57
v_fma_f32 v10, v10, s42, -v57
v_fma_f32 v11, v11, s42, -v57
v_fma_f32 v12, v12, s42, -v57
v_fma_f32 v13, v13, s42, -v57
v_fma_f32 v14, v14, s42, -v57
v_fma_f32 v15, v15, s42, -v57
v_exp_f32 v8, v8
v_exp_f32 v9, v9
v_exp_f32 v10, v10
v_exp_f32 v11, v11
v_exp_f32 v12, v12
v_exp_f32 v13, v13
v_exp_f32 v14, v14
v_exp_f32 v15, v15
v_cvt_pk_bf16_f32 v8, v8, v9
v_cvt_pk_bf16_f32 v9, v10, v11
v_cvt_pk_bf16_f32 v10, v12, v13
v_cvt_pk_bf16_f32 v11, v14, v15
v_and_b32 v32, v8, v204
v_and_b32 v33, v9, v204
v_and_b32 v34, v10, v204
v_and_b32 v35, v11, v204
v_and_b32 v36, v8, v205
v_and_b32 v37, v9, v205
v_and_b32 v38, v10, v205
v_and_b32 v39, v11, v205
v_and_b32 v40, v8, v206
v_and_b32 v41, v9, v206
v_and_b32 v42, v10, v206
v_and_b32 v43, v11, v206
v_and_b32 v44, v8, v207
v_and_b32 v45, v9, v207
v_and_b32 v46, v10, v207
v_and_b32 v47, v11, v207
s_cmp_lg_u32 s60, 0
s_cbranch_scc1 L_ewv0
s_waitcnt vmcnt(24)
L_vgo0:
v_perm_b32 v16, v68, v64, v244
v_perm_b32 v17, v76, v72, v244
v_perm_b32 v18, v84, v80, v244
v_perm_b32 v19, v92, v88, v244
v_perm_b32 v20, v68, v64, v245
v_perm_b32 v21, v76, v72, v245
v_perm_b32 v22, v84, v80, v245
v_perm_b32 v23, v92, v88, v245
v_mfma_f32_16x16x32_bf16 v[24:27], v[16:19], v[32:35], v[24:27]
s_nop 0
v_mfma_f32_16x16x32_bf16 v[28:31], v[20:23], v[32:35], v[28:31]
v_perm_b32 v16, v69, v65, v244
v_perm_b32 v17, v77, v73, v244
v_perm_b32 v18, v85, v81, v244
v_perm_b32 v19, v93, v89, v244
v_perm_b32 v20, v69, v65, v245
v_perm_b32 v21, v77, v73, v245
v_perm_b32 v22, v85, v81, v245
v_perm_b32 v23, v93, v89, v245
v_mfma_f32_16x16x32_bf16 v[24:27], v[16:19], v[36:39], v[24:27]
s_nop 0
v_mfma_f32_16x16x32_bf16 v[28:31], v[20:23], v[36:39], v[28:31]
v_perm_b32 v16, v70, v66, v244
v_perm_b32 v17, v78, v74, v244
v_perm_b32 v18, v86, v82, v244
v_perm_b32 v19, v94, v90, v244
v_perm_b32 v20, v70, v66, v245
v_perm_b32 v21, v78, v74, v245
v_perm_b32 v22, v86, v82, v245
v_perm_b32 v23, v94, v90, v245
v_mfma_f32_16x16x32_bf16 v[24:27], v[16:19], v[40:43], v[24:27]
s_nop 0
v_mfma_f32_16x16x32_bf16 v[28:31], v[20:23], v[40:43], v[28:31]
v_perm_b32 v16, v71, v67, v244
v_perm_b32 v17, v79, v75, v244
v_perm_b32 v18, v87, v83, v244
v_perm_b32 v19, v95, v91, v244
v_perm_b32 v20, v71, v67, v245
v_perm_b32 v21, v79, v75, v245
v_perm_b32 v22, v87, v83, v245
v_perm_b32 v23, v95, v91, v245
v_mfma_f32_16x16x32_bf16 v[24:27], v[16:19], v[44:47], v[24:27]
s_nop 0
v_mfma_f32_16x16x32_bf16 v[28:31], v[20:23], v[44:47], v[28:31]
L_refill0:
s_cmp_lg_u32 s60, 0
s_cbranch_scc1 L_endstep0
s_waitcnt vmcnt(16)
s_mov_b64 exec, 1
ds_add_rtn_u32 v60, v63, v242 offset:2048
ds_read_b32 v61, v63 offset:2056
s_mov_b64 exec, -1
s_waitcnt lgkmcnt(0)
v_readfirstlane_b32 s52, v60
v_readfirstlane_b32 s3, v61
s_cmp_ge_u32 s52, 256
s_cbranch_scc1 L_endstep0
s_lshr_b32 s36, s52, 6
s_cmp_lg_u32 s36, s51
s_cbranch_scc1 L_ldph0
L_ldok0:
s_bfe_u32 s39, s52, 0x30003
s_lshl_b32 s39, s39, 17
s_and_b32 s38, s52, 7
s_lshl_b32 s38, s38, 13
s_add_u32 s39, s39, s38
s_cmp_ge_u32 s52, s3
s_cselect_b32 s38, -1, 0
s_bitset0_b32 s56, 0
s_and_b32 s37, s38, 1
s_or_b32 s56, s56, s37
v_and_b32 v1, s38, v197
v_add_u32 v2, s39, v196
v_add_u32 v3, 1024, v2
v_add_u32 v2, v2, v1
v_sub_u32 v3, v3, v1
v_add_u32 v4, 0x1000, v2
v_add_u32 v5, 0x1000, v3
buffer_load_dwordx4 v[64:67], v2, s[12:15], 0 offen offset:0 nt
buffer_load_dwordx4 v[68:71], v3, s[12:15], 0 offen offset:0 nt
buffer_load_dwordx4 v[72:75], v2, s[12:15], 0 offen offset:2048 nt
buffer_load_dwordx4 v[76:79], v3, s[12:15], 0 offen offset:2048 nt
buffer_load_dwordx4 v[80:83], v4, s[12:15], 0 offen offset:0 nt
buffer_load_dwordx4 v[84:87], v5, s[12:15], 0 offen offset:0 nt
buffer_load_dwordx4 v[88:91], v4, s[12:15], 0 offen offset:2048 nt
buffer_load_dwordx4 v[92:95], v5, s[12:15], 0 offen offset:2048 nt
L_body1:
s_lshr_b32 s65, s53, 6
s_cmp_lg_u32 s65, s50
s_cbranch_scc1 L_tcall1
L_tok1:
s_and_b32 s38, s53, 63
s_lshl_b32 s38, s38, 9
s_lshr_b32 s39, s53, 7
s_lshl_b32 s39, s39, 15
s_add_u32 s38, s38, s39
v_add_u32 v7, s38, v249
s_bitcmp0_b32 s50, 0
s_cbranch_scc1 L_k1
ds_read_b128 v[8:11], v7
ds_read_b128 v[12:15], v7 offset:16
s_waitcnt lgkmcnt(0)
v_fma_f32 v8, v8, s42, -v57
v_fma_f32 v9, v9, s42, -v57
v_fma_f32 v10, v10, s42, -v57
v_fma_f32 v11, v11, s42, -v57
v_fma_f32 v12, v12, s42, -v57
v_fma_f32 v13, v13, s42, -v57
v_fma_f32 v14, v14, s42, -v57
v_fma_f32 v15, v15, s42, -v57
v_exp_f32 v8, v8
v_exp_f32 v9, v9
v_exp_f32 v10, v10
v_exp_f32 v11, v11
v_exp_f32 v12, v12
v_exp_f32 v13, v13
v_exp_f32 v14, v14
v_exp_f32 v15, v15
v_cvt_pk_bf16_f32 v8, v8, v9
v_cvt_pk_bf16_f32 v9, v10, v11
v_cvt_pk_bf16_f32 v10, v12, v13
v_cvt_pk_bf16_f32 v11, v14, v15
v_and_b32 v32, v8, v204
v_and_b32 v33, v9, v204
v_and_b32 v34, v10, v204
v_and_b32 v35, v11, v204
v_and_b32 v36, v8, v205
v_and_b32 v37, v9, v205
v_and_b32 v38, v10, v205
v_and_b32 v39, v11, v205
v_and_b32 v40, v8, v206
v_and_b32 v41, v9, v206
v_and_b32 v42, v10, v206
v_and_b32 v43, v11, v206
v_and_b32 v44, v8, v207
v_and_b32 v45, v9, v207
v_and_b32 v46, v10, v207
v_and_b32 v47, v11, v207
s_cmp_lg_u32 s60, 0
s_cbranch_scc1 L_ewv1
s_waitcnt vmcnt(24)
L_vgo1:
v_perm_b32 v16, v100, v96, s40
v_perm_b32 v17, v108, v104, s40
v_perm_b32 v18, v116, v112, s40
v_perm_b32 v19, v124, v120, s40
v_perm_b32 v20, v100, v96, s41
v_perm_b32 v21, v108, v104, s41
v_perm_b32 v22, v116, v112, s41
v_perm_b32 v23, v124, v120, s41
v_mfma_f32_16x16x32_bf16 v[24:27], v[16:19], v[32:35], v[24:27]
s_nop 0
v_mfma_f32_16x16x32_bf16 v[28:31], v[20:23], v[32:35], v[28:31]
v_perm_b32 v16, v101, v97, s40
v_perm_b32 v17, v109, v105, s40
v_perm_b32 v18, v117, v113, s40
v_perm_b32 v19, v125, v121, s40
v_perm_b32 v20, v101, v97, s41
v_perm_b32 v21, v109, v105, s41
v_perm_b32 v22, v117, v113, s41
v_perm_b32 v23, v125, v121, s41
v_mfma_f32_16x16x32_bf16 v[24:27], v[16:19], v[36:39], v[24:27]
s_nop 0
v_mfma_f32_16x16x32_bf16 v[28:31], v[20:23], v[36:39], v[28:31]
v_perm_b32 v16, v102, v98, s40
v_perm_b32 v17, v110, v106, s40
v_perm_b32 v18, v118, v114, s40
v_perm_b32 v19, v126, v122, s40
v_perm_b32 v20, v102, v98, s41
v_perm_b32 v21, v110, v106, s41
v_perm_b32 v22, v118, v114, s41
v_perm_b32 v23, v126, v122, s41
v_mfma_f32_16x16x32_bf16 v[24:27], v[16:19], v[40:43], v[24:27]
s_nop 0
v_mfma_f32_16x16x32_bf16 v[28:31], v[20:23], v[40:43], v[28:31]
v_perm_b32 v16, v103, v99, s40
v_perm_b32 v17, v111, v107, s40
v_perm_b32 v18, v119, v115, s40
v_perm_b32 v19, v127, v123, s40
v_perm_b32 v20, v103, v99, s41
v_perm_b32 v21, v111, v107, s41
v_perm_b32 v22, v119, v115, s41
v_perm_b32 v23, v127, v123, s41
v_mfma_f32_16x16x32_bf16 v[24:27], v[16:19], v[44:47], v[24:27]
s_nop 0
v_mfma_f32_16x16x32_bf16 v[28:31], v[20:23], v[44:47], v[28:31]
L_refill1:
s_cmp_lg_u32 s60, 0
s_cbranch_scc1 L_endstep1
s_waitcnt vmcnt(16)
s_mov_b64 exec, 1
ds_add_rtn_u32 v60, v63, v242 offset:2048
ds_read_b32 v61, v63 offset:2056
s_mov_b64 exec, -1
s_waitcnt lgkmcnt(0)
v_readfirstlane_b32 s53, v60
v_readfirstlane_b32 s3, v61
s_cmp_ge_u32 s53, 256
s_cbranch_scc1 L_endstep1
s_lshr_b32 s36, s53, 6
s_cmp_lg_u32 s36, s51
s_cbranch_scc1 L_ldph1
L_ldok1:
s_bfe_u32 s39, s53, 0x30003
s_lshl_b32 s39, s39, 17
s_and_b32 s38, s53, 7
s_lshl_b32 s38, s38, 13
s_add_u32 s39, s39, s38
v_add_u32 v2, s39, v196
v_add_u32 v3, 0x1000, v2
buffer_load_dwordx4 v[96:99], v2, s[12:15], 0 offen offset:0 nt
buffer_load_dwordx4 v[100:103], v2, s[12:15], 0 offen offset:1024 nt
buffer_load_dwordx4 v[104:107], v2, s[12:15], 0 offen offset:2048 nt
buffer_load_dwordx4 v[108:111], v2, s[12:15], 0 offen offset:3072 nt
buffer_load_dwordx4 v[112:115], v3, s[12:15], 0 offen offset:0 nt
buffer_load_dwordx4 v[116:119], v3, s[12:15], 0 offen offset:1024 nt
buffer_load_dwordx4 v[120:123], v3, s[12:15], 0 offen offset:2048 nt
buffer_load_dwordx4 v[124:127], v3, s[12:15], 0 offen offset:3072 nt
L_body2:
s_lshr_b32 s65, s54, 6
s_cmp_lg_u32 s65, s50
s_cbranch_scc1 L_tcall2
L_tok2:
s_and_b32 s38, s54, 63
s_lshl_b32 s38, s38, 9
s_lshr_b32 s39, s54, 7
s_lshl_b32 s39, s39, 15
s_add_u32 s38, s38, s39
v_add_u32 v7, s38, v249
s_bitcmp0_b32 s50, 0
s_cbranch_scc1 L_k2
ds_read_b128 v[8:11], v7
ds_read_b128 v[12:15], v7 offset:16
s_bitcmp1_b32 s56, 2
s_cselect_b64 vcc, -1, 0
v_mov_b32 v244, s40
v_mov_b32 v245, s41
v_cndmask_b32 v244, v244, v246, vcc
v_cndmask_b32 v245, v245, v247, vcc
s_waitcnt lgkmcnt(0)
v_fma_f32 v8, v8, s42, -v57
v_fma_f32 v9, v9, s42, -v57
v_fma_f32 v10, v10, s42, -v57
v_fma_f32 v11, v11, s42, -v57
v_fma_f32 v12, v12, s42, -v57
v_fma_f32 v13, v13, s42, -v57
v_fma_f32 v14, v14, s42, -v57
v_fma_f32 v15, v15, s42, -v57
v_exp_f32 v8, v8
v_exp_f32 v9, v9
v_exp_f32 v10, v10
v_exp_f32 v11, v11
v_exp_f32 v12, v12
v_exp_f32 v13, v13
v_exp_f32 v14, v14
v_exp_f32 v15, v15
v_cvt_pk_bf16_f32 v8, v8, v9
v_cvt_pk_bf16_f32 v9, v10, v11
v_cvt_pk_bf16_f32 v10, v12, v13
v_cvt_pk_bf16_f32 v11, v14, v15
v_and_b32 v32, v8, v204
v_and_b32 v33, v9, v204
v_and_b32 v34, v10, v204
v_and_b32 v35, v11, v204
v_and_b32 v36, v8, v205
v_and_b32 v37, v9, v205
v_and_b32 v38, v10, v205
v_and_b32 v39, v11, v205
v_and_b32 v40, v8, v206
v_and_b32 v41, v9, v206
v_and_b32 v42, v10, v206
v_and_b32 v43, v11, v206
v_and_b32 v44, v8, v207
v_and_b32 v45, v9, v207
v_and_b32 v46, v10, v207
v_and_b32 v47, v11, v207
s_cmp_lg_u32 s60, 0
s_cbranch_scc1 L_ewv2
s_waitcnt vmcnt(24)
L_vgo2:
v_perm_b32 v16, v132, v128, v244
v_perm_b32 v17, v140, v136, v244
v_perm_b32 v18, v148, v144, v244
v_perm_b32 v19, v156, v152, v244
v_perm_b32 v20, v132, v128, v245
v_perm_b32 v21, v140, v136, v245
v_perm_b32 v22, v148, v144, v245
v_perm_b32 v23, v156, v152, v245
v_mfma_f32_16x16x32_bf16 v[24:27], v[16:19], v[32:35], v[24:27]
s_nop 0
v_mfma_f32_16x16x32_bf16 v[28:31], v[20:23], v[32:35], v[28:31]
v_perm_b32 v16, v133, v129, v244
v_perm_b32 v17, v141, v137, v244
v_perm_b32 v18, v149, v145, v244
v_perm_b32 v19, v157, v153, v244
v_perm_b32 v20, v133, v129, v245
v_perm_b32 v21, v141, v137, v245
v_perm_b32 v22, v149, v145, v245
v_perm_b32 v23, v157, v153, v245
v_mfma_f32_16x16x32_bf16 v[24:27], v[16:19], v[36:39], v[24:27]
s_nop 0
v_mfma_f32_16x16x32_bf16 v[28:31], v[20:23], v[36:39], v[28:31]
v_perm_b32 v16, v134, v130, v244
v_perm_b32 v17, v142, v138, v244
v_perm_b32 v18, v150, v146, v244
v_perm_b32 v19, v158, v154, v244
v_perm_b32 v20, v134, v130, v245
v_perm_b32 v21, v142, v138, v245
v_perm_b32 v22, v150, v146, v245
v_perm_b32 v23, v158, v154, v245
v_mfma_f32_16x16x32_bf16 v[24:27], v[16:19], v[40:43], v[24:27]
s_nop 0
v_mfma_f32_16x16x32_bf16 v[28:31], v[20:23], v[40:43], v[28:31]
v_perm_b32 v16, v135, v131, v244
v_perm_b32 v17, v143, v139, v244
v_perm_b32 v18, v151, v147, v244
v_perm_b32 v19, v159, v155, v244
v_perm_b32 v20, v135, v131, v245
v_perm_b32 v21, v143, v139, v245
v_perm_b32 v22, v151, v147, v245
v_perm_b32 v23, v159, v155, v245
v_mfma_f32_16x16x32_bf16 v[24:27], v[16:19], v[44:47], v[24:27]
s_nop 0
v_mfma_f32_16x16x32_bf16 v[28:31], v[20:23], v[44:47], v[28:31]
L_refill2:
s_cmp_lg_u32 s60, 0
s_cbranch_scc1 L_endstep2
s_waitcnt vmcnt(16)
s_mov_b64 exec, 1
ds_add_rtn_u32 v60, v63, v242 offset:2048
ds_read_b32 v61, v63 offset:2056
s_mov_b64 exec, -1
s_waitcnt lgkmcnt(0)
v_readfirstlane_b32 s54, v60
v_readfirstlane_b32 s3, v61
s_cmp_ge_u32 s54, 256
s_cbranch_scc1 L_endstep2
s_lshr_b32 s36, s54, 6
s_cmp_lg_u32 s36, s51
s_cbranch_scc1 L_ldph2
L_ldok2:
s_bfe_u32 s39, s54, 0x30003
s_lshl_b32 s39, s39, 17
s_and_b32 s38, s54, 7
s_lshl_b32 s38, s38, 13
s_add_u32 s39, s39, s38
s_cmp_ge_u32 s54, s3
s_cselect_b32 s38, -1, 0
s_bitset0_b32 s56, 2
s_and_b32 s37, s38, 4
s_or_b32 s56, s56, s37
v_and_b32 v1, s38, v197
v_add_u32 v2, s39, v196
v_add_u32 v3, 1024, v2
v_add_u32 v2, v2, v1
v_sub_u32 v3, v3, v1
v_add_u32 v4, 0x1000, v2
v_add_u32 v5, 0x1000, v3
buffer_load_dwordx4 v[128:131], v2, s[12:15], 0 offen offset:0 nt
buffer_load_dwordx4 v[132:135], v3, s[12:15], 0 offen offset:0 nt
buffer_load_dwordx4 v[136:139], v2, s[12:15], 0 offen offset:2048 nt
buffer_load_dwordx4 v[140:143], v3, s[12:15], 0 offen offset:2048 nt
buffer_load_dwordx4 v[144:147], v4, s[12:15], 0 offen offset:0 nt
buffer_load_dwordx4 v[148:151], v5, s[12:15], 0 offen offset:0 nt
buffer_load_dwordx4 v[152:155], v4, s[12:15], 0 offen offset:2048 nt
buffer_load_dwordx4 v[156:159], v5, s[12:15], 0 offen offset:2048 nt
L_body3:
s_lshr_b32 s65, s55, 6
s_cmp_lg_u32 s65, s50
s_cbranch_scc1 L_tcall3
L_tok3:
s_and_b32 s38, s55, 63
s_lshl_b32 s38, s38, 9
s_lshr_b32 s39, s55, 7
s_lshl_b32 s39, s39, 15
s_add_u32 s38, s38, s39
v_add_u32 v7, s38, v249
s_bitcmp0_b32 s50, 0
s_cbranch_scc1 L_k3
ds_read_b128 v[8:11], v7
ds_read_b128 v[12:15], v7 offset:16
s_waitcnt lgkmcnt(0)
v_fma_f32 v8, v8, s42, -v57
v_fma_f32 v9, v9, s42, -v57
v_fma_f32 v10, v10, s42, -v57
v_fma_f32 v11, v11, s42, -v57
v_fma_f32 v12, v12, s42, -v57
v_fma_f32 v13, v13, s42, -v57
v_fma_f32 v14, v14, s42, -v57
v_fma_f32 v15, v15, s42, -v57
v_exp_f32 v8, v8
v_exp_f32 v9, v9
v_exp_f32 v10, v10
v_exp_f32 v11, v11
v_exp_f32 v12, v12
v_exp_f32 v13, v13
v_exp_f32 v14, v14
v_exp_f32 v15, v15
v_cvt_pk_bf16_f32 v8, v8, v9
v_cvt_pk_bf16_f32 v9, v10, v11
v_cvt_pk_bf16_f32 v10, v12, v13
v_cvt_pk_bf16_f32 v11, v14, v15
v_and_b32 v32, v8, v204
v_and_b32 v33, v9, v204
v_and_b32 v34, v10, v204
v_and_b32 v35, v11, v204
v_and_b32 v36, v8, v205
v_and_b32 v37, v9, v205
v_and_b32 v38, v10, v205
v_and_b32 v39, v11, v205
v_and_b32 v40, v8, v206
v_and_b32 v41, v9, v206
v_and_b32 v42, v10, v206
v_and_b32 v43, v11, v206
v_and_b32 v44, v8, v207
v_and_b32 v45, v9, v207
v_and_b32 v46, v10, v207
v_and_b32 v47, v11, v207
s_cmp_lg_u32 s60, 0
s_cbranch_scc1 L_ewv3
s_waitcnt vmcnt(24)
L_vgo3:
v_perm_b32 v16, v164, v160, s40
v_perm_b32 v17, v172, v168, s40
v_perm_b32 v18, v180, v176, s40
v_perm_b32 v19, v188, v184, s40
v_perm_b32 v20, v164, v160, s41
v_perm_b32 v21, v172, v168, s41
v_perm_b32 v22, v180, v176, s41
v_perm_b32 v23, v188, v184, s41
v_mfma_f32_16x16x32_bf16 v[24:27], v[16:19], v[32:35], v[24:27]
s_nop 0
v_mfma_f32_16x16x32_bf16 v[28:31], v[20:23], v[32:35], v[28:31]
v_perm_b32 v16, v165, v161, s40
v_perm_b32 v17, v173, v169, s40
v_perm_b32 v18, v181, v177, s40
v_perm_b32 v19, v189, v185, s40
v_perm_b32 v20, v165, v161, s41
v_perm_b32 v21, v173, v169, s41
v_perm_b32 v22, v181, v177, s41
v_perm_b32 v23, v189, v185, s41
v_mfma_f32_16x16x32_bf16 v[24:27], v[16:19], v[36:39], v[24:27]
s_nop 0
v_mfma_f32_16x16x32_bf16 v[28:31], v[20:23], v[36:39], v[28:31]
v_perm_b32 v16, v166, v162, s40
v_perm_b32 v17, v174, v170, s40
v_perm_b32 v18, v182, v178, s40
v_perm_b32 v19, v190, v186, s40
v_perm_b32 v20, v166, v162, s41
v_perm_b32 v21, v174, v170, s41
v_perm_b32 v22, v182, v178, s41
v_perm_b32 v23, v190, v186, s41
v_mfma_f32_16x16x32_bf16 v[24:27], v[16:19], v[40:43], v[24:27]
s_nop 0
v_mfma_f32_16x16x32_bf16 v[28:31], v[20:23], v[40:43], v[28:31]
v_perm_b32 v16, v167, v163, s40
v_perm_b32 v17, v175, v171, s40
v_perm_b32 v18, v183, v179, s40
v_perm_b32 v19, v191, v187, s40
v_perm_b32 v20, v167, v163, s41
v_perm_b32 v21, v175, v171, s41
v_perm_b32 v22, v183, v179, s41
v_perm_b32 v23, v191, v187, s41
v_mfma_f32_16x16x32_bf16 v[24:27], v[16:19], v[44:47], v[24:27]
s_nop 0
v_mfma_f32_16x16x32_bf16 v[28:31], v[20:23], v[44:47], v[28:31]
L_refill3:
s_cmp_lg_u32 s60, 0
s_cbranch_scc1 L_endstep3
s_waitcnt vmcnt(16)
s_mov_b64 exec, 1
ds_add_rtn_u32 v60, v63, v242 offset:2048
ds_read_b32 v61, v63 offset:2056
s_mov_b64 exec, -1
s_waitcnt lgkmcnt(0)
v_readfirstlane_b32 s55, v60
v_readfirstlane_b32 s3, v61
s_cmp_ge_u32 s55, 256
s_cbranch_scc1 L_endstep3
s_lshr_b32 s36, s55, 6
s_cmp_lg_u32 s36, s51
s_cbranch_scc1 L_ldph3
L_ldok3:
s_bfe_u32 s39, s55, 0x30003
s_lshl_b32 s39, s39, 17
s_and_b32 s38, s55, 7
s_lshl_b32 s38, s38, 13
s_add_u32 s39, s39, s38
v_add_u32 v2, s39, v196
v_add_u32 v3, 0x1000, v2
buffer_load_dwordx4 v[160:163], v2, s[12:15], 0 offen offset:0 nt
buffer_load_dwordx4 v[164:167], v2, s[12:15], 0 offen offset:1024 nt
buffer_load_dwordx4 v[168:171], v2, s[12:15], 0 offen offset:2048 nt
buffer_load_dwordx4 v[172:175], v2, s[12:15], 0 offen offset:3072 nt
buffer_load_dwordx4 v[176:179], v3, s[12:15], 0 offen offset:0 nt
buffer_load_dwordx4 v[180:183], v3, s[12:15], 0 offen offset:1024 nt
buffer_load_dwordx4 v[184:187], v3, s[12:15], 0 offen offset:2048 nt
buffer_load_dwordx4 v[188:191], v3, s[12:15], 0 offen offset:3072 nt
s_branch L_body0
L_exit:
s_mov_b32 s65, 4
s_call_b64 s[16:17], L_trans
buffer_load_dwordx4 v[208:211], v251, s[24:27], s62 offen offset:0 nt
buffer_load_dwordx4 v[212:215], v251, s[24:27], s62 offen offset:1024 nt
buffer_load_dwordx4 v[216:219], v251, s[24:27], s62 offen offset:2048 nt
buffer_load_dwordx4 v[220:223], v251, s[24:27], s62 offen offset:3072 nt
buffer_load_dwordx4 v[224:227], v251, s[24:27], s63 offen offset:0 nt
buffer_load_dwordx4 v[228:231], v251, s[24:27], s63 offen offset:1024 nt
buffer_load_dwordx4 v[232:235], v251, s[24:27], s63 offen offset:2048 nt
buffer_load_dwordx4 v[236:239], v251, s[24:27], s63 offen offset:3072 nt
s_waitcnt lgkmcnt(0)
s_barrier
ds_read_b128 v[24:27], v200 offset:6144
ds_read_b128 v[28:31], v200 offset:8320
ds_read_b128 v[32:35], v200 offset:10496
ds_read_b128 v[36:39], v200 offset:12672
ds_read_b32 v40, v201 offset:2080
ds_read_b32 v41, v63 offset:2060
s_waitcnt lgkmcnt(0)
v_add_f32 v24, v24, v28
v_add_f32 v32, v32, v36
v_add_f32 v25, v25, v29
v_add_f32 v33, v33, v37
v_add_f32 v26, v26, v30
v_add_f32 v34, v34, v38
v_add_f32 v27, v27, v31
v_add_f32 v35, v35, v39
v_add_f32 v48, v24, v32
v_add_f32 v49, v25, v33
v_add_f32 v50, v26, v34
v_add_f32 v51, v27, v35
v_mul_f32 v48, v48, v40
v_mul_f32 v49, v49, v40
v_mul_f32 v50, v50, v40
v_mul_f32 v51, v51, v40
v_min_u32 v48, -2, v48
v_min_u32 v49, -2, v49
v_min_u32 v50, -2, v50
v_min_u32 v51, -2, v51
buffer_store_dwordx4 v[48:51], v202, s[20:23], s32 offen sc1
v_lshrrev_b32 v8, 4, v0
v_mul_u32_u24 v9, 17408, v8
v_bfe_u32 v10, v0, 3, 1
v_mul_u32_u24 v10, 2176, v10
v_add_u32 v9, v9, v10
v_and_b32 v11, 7, v0
s_lshl_b32 s36, s33, 7
v_lshl_add_u32 v10, v11, 4, v9
v_add_u32 v10, s36, v10
s_add_u32 s52, s57, 0
s_add_u32 s53, s57, 4352
s_add_u32 s54, s57, 8704
s_add_u32 s55, s57, 13056
s_lshl_b32 s36, s33, 8
s_add_u32 s36, s36, 2560
v_lshlrev_b32 v56, 6, v8
v_lshl_add_u32 v56, v11, 3, v56
v_add_u32 v56, s36, v56
v_and_b32 v12, 3, v0
v_lshlrev_b32 v57, 6, v12
v_lshl_add_u32 v57, v8, 4, v57
v_add_u32 v57, s36, v57
s_mul_i32 s36, s33, 544
v_lshl_add_u32 v58, v0, 3, s36
v_add_u32 v254, 23552, v254
v_lshrrev_b32 v13, 3, v0
v_lshlrev_b32 v59, 12, v13
v_lshl_add_u32 v59, v11, 4, v59
s_lshl_b32 s61, s28, 2
s_add_u32 s61, s61, s59
s_lshl_b32 s61, s61, 17
s_add_u32 s61, s61, 0x100000
s_lshl_b32 s63, s29, 2
s_add_u32 s63, s63, s58
s_lshl_b32 s36, s33, 3
s_add_u32 s36, s36, s63
v_add_u32 v13, s36, v13
v_and_b32 v13, 31, v13
v_lshl_add_u32 v59, v13, 7, v59
s_lshl_b32 s37, s33, 15
s_add_u32 s62, s61, s37
s_lshl_b32 s36, s63, 12
s_add_u32 s61, s61, s36
s_lshl_b32 s37, s33, 10
s_add_u32 s61, s61, s37
s_mov_b32 s12, s48
s_mov_b32 s13, s49
s_mov_b32 s14, 0x2000
s_mov_b32 s15, 0x20000
s_lshr_b32 s3, s63, 3
s_lshl_b32 s3, s3, 11
s_lshl_b32 s37, s28, 10
s_add_u32 s3, s3, s37
s_lshl_b32 s37, s59, 8
s_add_u32 s3, s3, s37
s_and_b32 s37, s63, 7
s_lshl_b32 s37, s37, 5
s_add_u32 s3, s3, s37
v_lshlrev_b32 v14, 3, v11
s_lshl_b32 s37, s33, 6
v_add_u32 v15, s37, v14
v_readfirstlane_b32 s50, v41
s_mov_b64 s[94:95], -1
s_mov_b64 s[96:97], -1
s_mov_b64 s[98:99], -1
s_mov_b64 s[100:101], -1
s_cmp_eq_u32 s50, 0
s_cbranch_scc1 L_nowarm
buffer_load_dwordx4 v[32:35], v241, s[20:23], s61 offen sc1
s_waitcnt vmcnt(2)
s_branch L_warmed
L_nowarm:
s_waitcnt vmcnt(1)
L_warmed:
v_perm_b32 v96, v212, v208, s40
v_perm_b32 v100, v212, v208, s41
v_perm_b32 v97, v220, v216, s40
v_perm_b32 v101, v220, v216, s41
v_perm_b32 v98, v228, v224, s40
v_perm_b32 v102, v228, v224, s41
v_perm_b32 v99, v236, v232, s40
v_perm_b32 v103, v236, v232, s41
v_perm_b32 v104, v213, v209, s40
v_perm_b32 v108, v213, v209, s41
v_perm_b32 v105, v221, v217, s40
v_perm_b32 v109, v221, v217, s41
v_perm_b32 v106, v229, v225, s40
v_perm_b32 v110, v229, v225, s41
v_perm_b32 v107, v237, v233, s40
v_perm_b32 v111, v237, v233, s41
v_perm_b32 v112, v214, v210, s40
v_perm_b32 v116, v214, v210, s41
v_perm_b32 v113, v222, v218, s40
v_perm_b32 v117, v222, v218, s41
v_perm_b32 v114, v230, v226, s40
v_perm_b32 v118, v230, v226, s41
v_perm_b32 v115, v238, v234, s40
v_perm_b32 v119, v238, v234, s41
v_perm_b32 v120, v215, v211, s40
v_perm_b32 v124, v215, v211, s41
v_perm_b32 v121, v223, v219, s40
v_perm_b32 v125, v223, v219, s41
v_perm_b32 v122, v231, v227, s40
v_perm_b32 v126, v231, v227, s41
v_perm_b32 v123, v239, v235, s40
v_perm_b32 v127, v239, v235, s41
s_waitcnt vmcnt(0)
L_p1:
s_mov_b64 exec, s[94:95]
s_cbranch_execz L_p1s0
buffer_load_dwordx4 v[64:67], v10, s[20:23], s52 offen sc1
L_p1s0:
s_mov_b64 exec, s[96:97]
s_cbranch_execz L_p1s1
buffer_load_dwordx4 v[68:71], v10, s[20:23], s53 offen sc1
L_p1s1:
s_mov_b64 exec, s[98:99]
s_cbranch_execz L_p1s2
buffer_load_dwordx4 v[72:75], v10, s[20:23], s54 offen sc1
L_p1s2:
s_mov_b64 exec, s[100:101]
s_cbranch_execz L_p1s3
buffer_load_dwordx4 v[76:79], v10, s[20:23], s55 offen sc1
L_p1s3:
s_mov_b64 exec, -1
s_waitcnt vmcnt(0)
v_max3_u32 v16, v64, v65, v66
v_max3_u32 v17, v68, v69, v70
v_max3_u32 v18, v72, v73, v74
v_max3_u32 v19, v76, v77, v78
v_max_u32 v16, v16, v67
v_max_u32 v17, v17, v71
v_max_u32 v18, v18, v75
v_max_u32 v19, v19, v79
v_cmp_eq_u32 s[94:95], -1, v16
v_cmp_eq_u32 s[96:97], -1, v17
v_cmp_eq_u32 s[98:99], -1, v18
v_cmp_eq_u32 s[100:101], -1, v19
v_add_f32 v24, v64, v68
v_add_f32 v28, v72, v76
v_add_f32 v25, v65, v69
v_add_f32 v29, v73, v77
v_add_f32 v26, v66, v70
v_add_f32 v30, v74, v78
v_add_f32 v27, v67, v71
v_add_f32 v31, v75, v79
v_add_f32 v24, v24, v28
v_add_f32 v25, v25, v29
v_add_f32 v26, v26, v30
v_add_f32 v27, v27, v31
s_or_b64 s[36:37], s[94:95], s[96:97]
s_or_b64 s[38:39], s[98:99], s[100:101]
s_or_b64 s[38:39], s[38:39], s[36:37]
s_cbranch_scc0 L_got1
s_sub_u32 s64, s64, 1
s_cmp_gt_i32 s64, 0
s_cbranch_scc1 L_p1
L_got1:
v_add_f32_dpp v24, v24, v24 row_ror:8 row_mask:0xf bank_mask:0xf
v_add_f32_dpp v25, v25, v25 row_ror:8 row_mask:0xf bank_mask:0xf
v_add_f32_dpp v26, v26, v26 row_ror:8 row_mask:0xf bank_mask:0xf
v_add_f32_dpp v27, v27, v27 row_ror:8 row_mask:0xf bank_mask:0xf
v_cvt_pk_bf16_f32 v32, v24, v25
v_cvt_pk_bf16_f32 v33, v26, v27
ds_write_b64 v56, v[32:33]
ds_read_b128 v[36:39], v57
s_waitcnt lgkmcnt(0)
v_and_b32 v40, v36, v204
v_and_b32 v41, v37, v204
v_and_b32 v42, v38, v204
v_and_b32 v43, v39, v204
v_and_b32 v44, v36, v205
v_and_b32 v45, v37, v205
v_and_b32 v46, v38, v205
v_and_b32 v47, v39, v205
v_mfma_f32_16x16x32_bf16 v[128:131], v[96:99], v[40:43], 0
v_mfma_f32_16x16x32_bf16 v[132:135], v[100:103], v[40:43], 0
v_and_b32 v48, v36, v206
v_and_b32 v49, v37, v206
v_and_b32 v50, v38, v206
v_and_b32 v51, v39, v206
v_mfma_f32_16x16x32_bf16 v[128:131], v[104:107], v[44:47], v[128:131]
v_mfma_f32_16x16x32_bf16 v[132:135], v[108:111], v[44:47], v[132:135]
v_and_b32 v52, v36, v207
v_and_b32 v53, v37, v207
v_and_b32 v54, v38, v207
v_and_b32 v55, v39, v207
v_mfma_f32_16x16x32_bf16 v[128:131], v[112:115], v[48:51], v[128:131]
v_mfma_f32_16x16x32_bf16 v[132:135], v[116:119], v[48:51], v[132:135]
v_mfma_f32_16x16x32_bf16 v[128:131], v[120:123], v[52:55], v[128:131]
v_mfma_f32_16x16x32_bf16 v[132:135], v[124:127], v[52:55], v[132:135]
s_nop 7
ds_write2_b32 v254, v128, v132 offset0:0 offset1:1
ds_write2_b32 v254, v129, v133 offset0:8 offset1:9
ds_write2_b32 v254, v130, v134 offset0:16 offset1:17
ds_write2_b32 v254, v131, v135 offset0:24 offset1:25
s_waitcnt lgkmcnt(0)
s_barrier
ds_read_b64 v[16:17], v58 offset:23552
ds_read_b64 v[18:19], v58 offset:25728
ds_read_b64 v[20:21], v58 offset:27904
ds_read_b64 v[22:23], v58 offset:30080
v_mov_b32 v25, v62
v_mov_b32 v27, v62
s_waitcnt lgkmcnt(0)
v_add_f32 v16, v16, v18
v_add_f32 v17, v17, v19
v_add_f32 v20, v20, v22
v_add_f32 v21, v21, v23
v_add_f32 v24, v16, v20
v_add_f32 v26, v17, v21
s_mov_b64 vcc, -1
v_lshlrev_b32 v8, 2, v0
s_cmp_lg_u32 s50, 0
s_cbranch_scc1 L_opl
buffer_store_dwordx4 v[24:27], v59, s[20:23], s62 offen sc1
s_waitcnt vmcnt(0)
s_branch L_poll2
L_opl:
buffer_store_dwordx4 v[24:27], v59, s[20:23], s62 offen
L_poll2:
s_mov_b64 exec, vcc
buffer_load_dwordx4 v[32:35], v241, s[20:23], s61 offen sc1
s_mov_b64 exec, -1
s_waitcnt vmcnt(0)
v_xor_b32 v6, v33, v62
v_xor_b32 v7, v35, v62
v_or_b32 v6, v6, v7
v_cmp_ne_u32 vcc, 0, v6
s_cbranch_vccz L_got2
s_sub_u32 s64, s64, 1
s_cmp_gt_i32 s64, 0
s_cbranch_scc1 L_poll2
L_got2:
v_add_f32_dpp v32, v32, v32 row_ror:8 row_mask:0xf bank_mask:0xf
v_add_f32_dpp v34, v34, v34 row_ror:8 row_mask:0xf bank_mask:0xf
v_mov_b32 v33, v32
v_mov_b32 v35, v34
s_nop 0
v_permlane32_swap_b32 v32, v33
v_permlane32_swap_b32 v34, v35
v_add_f32 v32, v32, v33
v_add_f32 v34, v34, v35
v_mov_b32 v33, v32
v_mov_b32 v35, v34
s_nop 0
v_permlane16_swap_b32 v32, v33
v_permlane16_swap_b32 v34, v35
v_add_f32 v32, v32, v33
v_add_f32 v33, v34, v35
s_mov_b64 exec, 0xff
ds_write_b64 v15, v[32:33] offset:0
s_waitcnt lgkmcnt(0)
s_barrier
s_cmp_lg_u32 s33, 0
s_cbranch_scc1 L_sdone
ds_read2_b64 v[32:35], v14 offset0:0 offset1:8
ds_read2_b64 v[36:39], v14 offset0:16 offset1:24
s_waitcnt lgkmcnt(0)
v_add_f32 v32, v32, v34
v_add_f32 v33, v33, v35
v_add_f32 v36, v36, v38
v_add_f32 v37, v37, v39
v_add_f32 v32, v32, v36
v_add_f32 v33, v33, v37
v_cvt_pk_bf16_f32 v32, v32, v33
buffer_store_dword v32, v8, s[12:15], s3 offen
s_cmp_lg_u32 s2, 0
s_cbranch_scc1 L_sdone
s_mov_b32 s37, 0x20000
s_mov_b64 exec, 1
buffer_store_dword v62, v63, s[20:23], s37 offen sc1
L_sdone:
s_endpgm
.section .rodata,"a"
.p2align 6
.amdhsa_kernel concat_heads__gqa_block_cached__gqa_block_cached__decode_kernel
  .amdhsa_next_free_vgpr 256
  .amdhsa_next_free_sgpr 102
  .amdhsa_accum_offset 256
  .amdhsa_group_segment_fixed_size 0
  .amdhsa_kernarg_size 104
  .amdhsa_user_sgpr_count 2
  .amdhsa_user_sgpr_kernarg_segment_ptr 1
  .amdhsa_system_sgpr_workgroup_id_x 1
.end_amdhsa_kernel
```
